```python
import torch

def _softmax(x, axis=-1):
    return torch.softmax(x, dim=axis)
def _gelu(x):
    return torch.nn.functional.gelu(x, approximate="tanh")
def _silu(x):
    return torch.nn.functional.silu(x)
def _sigmoid(x):
    return torch.sigmoid(x)
def _layernorm(x, axis=-1, eps=1e-5):
    m = x.mean(dim=axis, keepdim=True)
    v = x.var(dim=axis, keepdim=True, unbiased=False)
    return (x - m) / torch.sqrt(v + eps)
def _scatter_add(tgt, idx, src, axis=0):
    return tgt.clone().index_add_(axis, idx, src)
def _segment_sum(src, seg, n):
    out = torch.zeros((n,) + src.shape[1:], dtype=src.dtype)
    return out.index_add_(0, seg, src)
def _pad(x, pw):
    flat = tuple(v for pair in reversed(pw) for v in pair)
    return torch.nn.functional.pad(x, flat)

kernel_name = 'gated_mix__linear_attn_block__glu_gated_reglu__prompt'

def setup_inputs():

    _w = (lambda a: (lambda t: t.to(torch.bfloat16) if t.is_floating_point() else t)(torch.as_tensor(a)))
    def _A_setup():
        B, S, D = 1, 2048, 448
        return {
            "x": _w((lambda *s: torch.randn(*s, dtype=torch.bfloat16) * 0.05)(B, S, D)),
            "wqkv": _w((lambda *s: torch.randn(*s, dtype=torch.bfloat16) * 0.8)(D, 3 * D)),
            "wo": _w((lambda *s: torch.randn(*s, dtype=torch.bfloat16) * 0.05)(D, D)),
        }
    _A_in = _A_setup()

    def _B_setup():
        B, S, D, F = 1, 2048, 448, 1792
        return {
            "x": _w((lambda *s: torch.randn(*s, dtype=torch.bfloat16) * 0.05)(B, S, D)),
            "W_gate": _w((lambda *s: torch.randn(*s, dtype=torch.bfloat16) * 1.6)(D, F) * (2.0 / D) ** 0.5),
            "W_up": _w((lambda *s: torch.randn(*s, dtype=torch.bfloat16) * 1.6)(D, F) * (2.0 / D) ** 0.5),
            "W_down": _w((lambda *s: torch.randn(*s, dtype=torch.bfloat16) * 1.6)(F, D) * (1.0 / F) ** 0.5),
        }
    _B_in = _B_setup()

    return {
        "A_x": _A_in["x"],
        "A_wqkv": _A_in["wqkv"],
        "A_wo": _A_in["wo"],
        "B_x": _B_in["x"],
        "B_W_gate": _B_in["W_gate"],
        "B_W_up": _B_in["W_up"],
        "B_W_down": _B_in["W_down"],
        "gate_w": _w((lambda *s: torch.randn(*s, dtype=torch.bfloat16) * 0.05)(448) * 16.0),
    }

def reference(A_x, A_wqkv, A_wo, B_x, B_W_gate, B_W_up, B_W_down, gate_w):
    def _A_ref(x, wqkv, wo):
        B, S, D = x.shape
        H = 16; Dh = D // H
        qkv = (lambda x, *d: x.permute(*d))((x @ wqkv).reshape(B, S, 3, H, Dh), 2, 0, 3, 1, 4)
        q, k, v = qkv[0], qkv[1], qkv[2]
        phi = lambda t: torch.where(t > 0, t + 1, torch.exp(t)) + 1e-6
        pq, pk = phi(q), phi(k)
        kv = torch.einsum("bhsd,bhse->bhde", pk, v)
        z = torch.einsum("bhsd->bhd", pk)
        num = torch.einsum("bhqd,bhde->bhqe", pq, kv)
        den = torch.einsum("bhqd,bhd->bhq", pq, z)[..., None] + 1e-6
        o = num / den
        return (lambda x, *d: x.permute(*d))(o, 0, 2, 1, 3).reshape(B, S, D) @ wo

    def _B_ref(x, W_gate, W_up, W_down):
        gate = torch.einsum("bsd,df->bsf", x, W_gate)
        up = torch.einsum("bsd,df->bsf", x, W_up)
        gate = gate * (lambda x, dt: x.to(dt))(gate > 0, gate.dtype)
        h = gate * up
        return torch.einsum("bsf,fd->bsd", h, W_down)

    x = A_x
    g = _sigmoid((x * gate_w).sum(-1, keepdims=True))
    a = _A_ref(x, A_wqkv, A_wo)
    b = _B_ref(x, B_W_gate, B_W_up, B_W_down)
    return g * a + (1 - g) * b
```

```asm
; @launch grid=(256,1,1) block=(256,1,1) lds=163840
.amdgcn_target "amdgcn-amd-amdhsa--gfx950"
.text
.globl gated_mix__linear_attn_block__glu_gated_reglu__prompt_kernel
.p2align 12
.p2align 8
.type gated_mix__linear_attn_block__glu_gated_reglu__prompt_kernel,@function
gated_mix__linear_attn_block__glu_gated_reglu__prompt_kernel:
    s_cmp_ge_u32 s2, 256
    s_cbranch_scc1 L_exit
    s_load_dwordx2 s[4:5], s[0:1], 0
    s_load_dwordx2 s[8:9], s[0:1], 32
    s_load_dwordx2 s[12:13], s[0:1], 40
    s_load_dwordx2 s[16:17], s[0:1], 8
    v_lshrrev_b32 v1, 6, v0
    v_and_b32 v0, 63, v0
    v_readfirstlane_b32 s40, v1
    s_lshr_b32 s48, s2, 3
    s_bfe_u32 s49, s2, 0x20001
    s_and_b32 s43, s2, 1
    s_lshl_b32 s3, s2, 2
    s_lshr_b32 s3, 0x26045230, s3
    s_and_b32 s3, s3, 7
    s_mov_b32 s6, 1835008
    s_mov_b32 s7, 0x20000
    v_lshrrev_b32 v24, 3, v0
    v_lshrrev_b32 v25, 4, v0
    v_and_b32 v26, 7, v0
    s_cmp_ge_u32 s48, 11
    s_cbranch_scc1 L_dec_ffn
    s_cmp_lt_u32 s48, 3
    s_cbranch_scc1 L_dec_x
L_att:
    s_sub_u32 s48, s48, 3
    s_lshr_b32 s50, s48, 2
    s_lshl1_add_u32 s41, s49, s50
    s_and_b32 s48, s48, 3
    s_lshl2_add_u32 s42, s43, s48
    s_add_u32 s45, s50, s48
    s_lshl_b32 s45, s45, 1
    s_lshr_b32 s45, 0x924924, s45
    s_bitcmp1_b32 s45, 0
    s_cselect_b32 s51, 0x3376111, 0
    s_bitcmp1_b32 s45, 1
    s_cselect_b32 s45, 0x3211230, s51
    s_xor_b32 s45, s45, 0x5642310
    s_bfe_u32 s60, s45, 0x30000
    s_add_u32 s60, s60, s3
    s_cmp_ge_u32 s60, 7
    s_cselect_b32 s51, 7, 0
    s_sub_u32 s60, s60, s51
    v_xor_b32 v27, v26, v25
    s_lshl2_add_u32 s44, s41, s40
    s_lshl_b32 s48, s44, 6
    v_add_u32 v28, s48, v24
    v_mul_u32_u24 v28, 896, v28
    v_lshl_add_u32 v1, v27, 4, v28
    v_xor_b32 v28, 64, v1
    v_add_u32 v2, 6144, v28
    v_add_u32 v3, 12288, v1
    v_add_u32 v4, 18432, v28
    v_and_b32 v27, 1, v25
    v_lshlrev_b32 v27, 2, v27
    v_xor_b32 v27, v27, v26
    v_add_u32 v29, 1, v27
    v_and_b32 v29, 8, v29
    s_and_b32 s49, s40, 1
    s_mul_i32 s48, s49, 192
    s_add_u32 s48, s48, s42
    s_mul_i32 s48, s48, 112
    v_mul_u32_u24 v28, 2688, v24
    v_lshl_add_u32 v5, v27, 4, v28
    v_add_u32 v5, s48, v5
    v_lshl_add_u32 v5, v29, 24, v5
    s_lshl_b32 s52, s40, 13
    s_lshl_b32 s53, s40, 12
    s_lshr_b32 s50, s40, 1
    s_mul_i32 s57, s50, 896
    s_add_u32 s57, s57, 896
    s_mov_b32 s18, 1204224
    s_mov_b32 s19, 0x20000
    s_add_u32 m0, s52, 0
    s_lshl_b32 s46, s60, 7
    s_waitcnt lgkmcnt(0)
    buffer_load_dwordx4 v1, s[4:7], s46 offen offset:0 lds
    buffer_load_dwordx4 v2, s[4:7], s46 offen offset:1024 lds
    buffer_load_dwordx4 v3, s[4:7], s46 offen offset:2048 lds
    buffer_load_dwordx4 v4, s[4:7], s46 offen offset:3072 lds
    s_add_u32 m0, s52, 4096
    s_add_u32 s56, s46, 28672
    buffer_load_dwordx4 v1, s[4:7], s56 offen offset:0 lds
    buffer_load_dwordx4 v2, s[4:7], s56 offen offset:1024 lds
    buffer_load_dwordx4 v3, s[4:7], s56 offen offset:2048 lds
    buffer_load_dwordx4 v4, s[4:7], s56 offen offset:3072 lds
    s_mul_i32 s47, s60, 172032
    s_add_u32 m0, s53, 32768
    s_add_u32 s47, s47, s57
    buffer_load_dwordx4 v5, s[16:19], s47 offen offset:0 lds
    s_mov_b64 exec, 0
    s_mov_b32 s55, s40
    s_cmp_eq_u32 s55, 0
    s_cbranch_scc1 L_pad_att_0
    s_cmp_eq_u32 s55, 1
    s_cbranch_scc1 L_pad_att_1
    s_cmp_eq_u32 s55, 2
    s_cbranch_scc1 L_pad_att_2
    s_branch L_att_main
L_dec_x:
    s_cmp_lg_u32 s48, 0
    s_cbranch_scc1 L_dec_y
    s_getpc_b64 s[58:59]
L_pc:
    v_lshlrev_b32 v1, 13, v1
    v_lshl_add_u32 v4, v0, 7, v1
    v_min_u32 v5, L_exit-L_pc, v4
    global_load_dword v6, v5, s[58:59]
    v_add_u32 v5, 0x8000, v4
    v_min_u32 v5, L_exit-L_pc, v5
    global_load_dword v7, v5, s[58:59]
    s_branch L_help
L_dec_y:
    s_lshl1_add_u32 s48, s49, s48
    s_cmp_ge_u32 s48, 8
    s_cbranch_scc1 L_exit
    s_add_u32 s48, s48, 10
    s_mov_b32 s49, 4
L_dec_ffn:
    s_sub_u32 s48, s48, 11
    s_mul_i32 s56, s48, 37
    s_lshr_b32 s56, s56, 8
    s_mul_i32 s51, s56, 7
    s_sub_u32 s42, s48, s51
    s_mul_i32 s41, s49, 3
    s_add_u32 s41, s41, s56
    s_add_u32 s45, s56, s42
L_ffn:
    s_mov_b32 s57, s45
    s_mul_i32 s51, s45, 128
    s_lshr_b32 s51, s51, 8
    s_mul_i32 s51, s51, 2
    s_sub_u32 s45, s45, s51
    s_add_u32 s60, s45, 0
    s_add_u32 s60, s60, s3
    s_cmp_ge_u32 s60, 7
    s_cselect_b32 s51, 7, 0
    s_sub_u32 s60, s60, s51
    s_mul_i32 s44, s43, 7
    s_add_u32 s44, s44, s42
    s_and_b32 s48, s40, 1
    s_lshl_b32 s50, s48, 2
    v_xor_b32 v29, s50, v25
    v_xor_b32 v28, v26, v29
    s_lshl_b32 s48, s43, 1
    s_xor_b32 s48, s48, s40
    s_xor_b32 s48, s48, 2
    s_lshl2_add_u32 s48, s41, s48
    s_mul_i32 s48, s48, 40
    v_add_u32 v27, s48, v24
    v_mul_u32_u24 v27, 896, v27
    v_lshl_add_u32 v1, v28, 4, v27
    v_xor_b32 v28, 64, v1
    v_add_u32 v2, 6144, v28
    v_add_u32 v3, 12288, v1
    v_add_u32 v4, 18432, v28
    v_add_u32 v5, 28672, v1
    v_and_b32 v28, 15, v0
    v_lshlrev_b32 v29, 1, v29
    v_xor_b32 v28, v28, v29
    v_mul_u32_u24 v27, 3584, v25
    v_lshl_add_u32 v6, v28, 4, v27
    s_mul_i32 s48, s40, 112
    s_add_u32 s48, s48, s44
    s_lshl_b32 s48, s48, 8
    v_add_u32 v6, s48, v6
    v_add_u32 v7, 12288, v6
    s_mul_i32 s52, s40, 5120
    s_lshl_b32 s53, s40, 12
    s_mov_b32 s10, 1605632
    s_mov_b32 s11, 0x20000
    s_mov_b32 s14, 1606656
    s_mov_b32 s15, 0x20000
    s_add_u32 m0, s52, 0
    s_lshl_b32 s46, s60, 7
    s_waitcnt lgkmcnt(0)
    buffer_load_dwordx4 v1, s[4:7], s46 offen offset:0 lds
    buffer_load_dwordx4 v2, s[4:7], s46 offen offset:1024 lds
    buffer_load_dwordx4 v3, s[4:7], s46 offen offset:2048 lds
    buffer_load_dwordx4 v4, s[4:7], s46 offen offset:3072 lds
    s_add_u32 m0, s52, 4096
    s_sub_u32 s12, s12, 1024
    buffer_load_dwordx4 v5, s[4:7], s46 offen offset:0 lds
    s_subb_u32 s13, s13, 0
    s_add_u32 m0, s53, 61440
    s_mul_i32 s47, s60, 229376
    buffer_load_dwordx4 v6, s[8:11], s47 offen offset:0 lds
    buffer_load_dwordx4 v6, s[12:15], s47 offen offset:1024 lds
    buffer_load_dwordx4 v7, s[8:11], s47 offen offset:2048 lds
    buffer_load_dwordx4 v7, s[12:15], s47 offen offset:3072 lds
    s_mov_b64 exec, 0
    s_mov_b32 s55, s40
L_tour_ffn:
    s_cmp_eq_u32 s55, 0
    s_cbranch_scc1 L_pad_ffn_0
    s_cmp_eq_u32 s55, 1
    s_cbranch_scc1 L_pad_ffn_1
    s_cmp_eq_u32 s55, 2
    s_cbranch_scc1 L_pad_ffn_2
    s_cmp_eq_u32 s55, 3
    s_cbranch_scc1 L_pad_ffn_3
    s_branch L_tourx_ffn
L_ret_ffn:
    s_add_u32 s55, s55, 4
    s_branch L_tour_ffn
L_tourx_ffn:
    s_mov_b64 exec, -1
    s_load_dwordx2 s[20:21], s[0:1], 48
    s_load_dwordx2 s[24:25], s[0:1], 16
    s_load_dwordx2 s[28:29], s[0:1], 80
    s_load_dwordx2 s[32:33], s[0:1], 64
    s_load_dwordx2 s[36:37], s[0:1], 72
    s_add_u32 s61, s45, 1
    s_cmp_ge_u32 s61, 2
    s_cselect_b32 s51, 2, 0
    s_sub_u32 s61, s61, s51
    s_add_u32 s61, s61, s3
    s_cmp_ge_u32 s61, 7
    s_cselect_b32 s51, 7, 0
    s_sub_u32 s61, s61, s51
    s_load_dwordx2 s[16:17], s[0:1], 80
    v_and_b32 v27, 15, v0
    v_bfe_u32 v28, v0, 1, 3
    v_xor_b32 v28, v28, v25
    v_lshlrev_b32 v28, 4, v28
    v_lshl_add_u32 v8, v27, 7, v28
    v_xor_b32 v9, 64, v8
    v_bfe_u32 v27, v0, 2, 3
    s_lshl_b32 s48, s40, 1
    v_xor_b32 v28, s48, v27
    v_and_b32 v29, 3, v0
    v_lshlrev_b32 v29, 3, v29
    v_lshl_add_u32 v28, v28, 5, v29
    v_and_b32 v27, 3, v27
    v_lshl_add_u32 v28, v27, 8, v28
    v_lshl_add_u32 v28, v25, 12, v28
    v_add_u32 v10, 61440, v28
    v_xor_b32 v11, 32, v10
    v_add_u32 v12, 65536, v10
    v_add_u32 v13, 65536, v11
    s_add_u32 s62, s45, 0
    s_add_u32 s62, s62, s3
    s_add_u32 s62, s62, 2
    s_cmp_ge_u32 s62, 7
    s_cselect_b32 s51, 7, 0
    s_sub_u32 s62, s62, s51
    s_add_u32 s63, s45, 1
    s_cmp_ge_u32 s63, 2
    s_cselect_b32 s51, 2, 0
    s_sub_u32 s63, s63, s51
    s_add_u32 s63, s63, s3
    s_add_u32 s63, s63, 2
    s_cmp_ge_u32 s63, 7
    s_cselect_b32 s51, 7, 0
    s_sub_u32 s63, s63, s51
    s_add_u32 s64, s45, 0
    s_add_u32 s64, s64, s3
    s_add_u32 s64, s64, 4
    s_cmp_ge_u32 s64, 7
    s_cselect_b32 s51, 7, 0
    s_sub_u32 s64, s64, s51
    s_add_u32 s65, s45, 1
    s_cmp_ge_u32 s65, 2
    s_cselect_b32 s51, 2, 0
    s_sub_u32 s65, s65, s51
    s_add_u32 s65, s65, s3
    s_add_u32 s65, s65, 4
    s_cmp_ge_u32 s65, 7
    s_cselect_b32 s51, 7, 0
    s_sub_u32 s65, s65, s51
    s_add_u32 s66, s3, 6
    s_cmp_ge_u32 s66, 7
    s_cselect_b32 s51, 7, 0
    s_sub_u32 s66, s66, s51
    s_mov_b32 s22, 1605632
    s_mov_b32 s23, 0x20000
    s_mov_b32 s26, 401408
    s_mov_b32 s27, 0x20000
    s_mov_b32 s30, 20971520
    s_mov_b32 s31, 0x20000
    s_mov_b32 s34, 1835008
    s_mov_b32 s35, 0x20000
    s_mov_b32 s18, 9437184
    s_mov_b32 s19, 0x20000
    v_lshlrev_b32 v28, 1, v25
    v_xor_b32 v28, v26, v28
    v_mul_u32_u24 v27, 896, v24
    v_lshl_add_u32 v14, v28, 4, v27
    s_lshl_b32 s48, s42, 7
    v_add_u32 v14, s48, v14
    v_add_u32 v15, 6144, v14
    v_add_u32 v16, 12288, v14
    v_add_u32 v17, 18432, v14
    v_add_u32 v18, 13312, v14
    v_add_u32 v19, 5120, v14
    v_bfe_u32 v27, v0, 3, 2
    v_xor_b32 v27, s40, v27
    v_lshl_add_u32 v28, v27, 5, v29
    v_lshrrev_b32 v27, 2, v0
    v_lshl_add_u32 v28, v27, 7, v28
    v_add_u32 v30, s53, v28
    v_xor_b32 v31, 32, v30
    v_xor_b32 v32, 64, v30
    v_xor_b32 v33, 96, v30
    v_add_u32 v38, 143360, v30
    v_add_u32 v39, 143360, v31
    v_add_u32 v40, 143360, v32
    v_add_u32 v41, 143360, v33
    v_add_u32 v34, 77824, v30
    v_add_u32 v35, 77824, v31
    v_add_u32 v36, 77824, v32
    v_add_u32 v37, 77824, v33
    s_lshl2_add_u32 s3, s44, s40
    s_lshl_b32 s3, s3, 10
    s_lshl_b32 s50, s40, 10
    s_mul_i32 s48, s43, 28672
    s_add_u32 s48, s48, s50
    s_and_b32 s57, s42, 1
    s_mul_i32 s57, s57, 3
    s_lshl1_add_u32 s57, s56, s57
    s_cmp_ge_u32 s57, 6
    s_cselect_b32 s51, 6, 0
    s_sub_u32 s57, s57, s51
    s_cmp_ge_u32 s57, s42
    s_addc_u32 s49, s57, 0
    s_lshl_b32 s49, s49, 12
    s_add_u32 s67, s49, s48
    s_add_u32 s57, s57, 1
    s_cmp_eq_u32 s57, 6
    s_cselect_b32 s57, 0, s57
    s_cmp_ge_u32 s57, s42
    s_addc_u32 s49, s57, 0
    s_lshl_b32 s49, s49, 12
    s_add_u32 s68, s49, s48
    s_add_u32 s57, s57, 1
    s_cmp_eq_u32 s57, 6
    s_cselect_b32 s57, 0, s57
    s_cmp_ge_u32 s57, s42
    s_addc_u32 s49, s57, 0
    s_lshl_b32 s49, s49, 12
    s_add_u32 s69, s49, s48
    s_add_u32 s57, s57, 1
    s_cmp_eq_u32 s57, 6
    s_cselect_b32 s57, 0, s57
    s_cmp_ge_u32 s57, s42
    s_addc_u32 s49, s57, 0
    s_lshl_b32 s49, s49, 12
    s_add_u32 s70, s49, s48
    s_add_u32 s57, s57, 1
    s_cmp_eq_u32 s57, 6
    s_cselect_b32 s57, 0, s57
    s_cmp_ge_u32 s57, s42
    s_addc_u32 s49, s57, 0
    s_lshl_b32 s49, s49, 12
    s_add_u32 s71, s49, s48
    s_waitcnt lgkmcnt(0)
    s_add_u32 m0, s53, 77824
    s_add_u32 s47, s47, 114688
    buffer_load_dwordx4 v6, s[8:11], s47 offen offset:0 lds
    buffer_load_dwordx4 v6, s[12:15], s47 offen offset:1024 lds
    buffer_load_dwordx4 v7, s[8:11], s47 offen offset:2048 lds
    buffer_load_dwordx4 v7, s[12:15], s47 offen offset:3072 lds
    s_add_u32 m0, s53, 126976
    s_mul_i32 s45, s67, 28
    buffer_load_dwordx4 v14, s[20:23], s45 offen offset:0 lds
    buffer_load_dwordx4 v15, s[20:23], s45 offen offset:1024 lds
    buffer_load_dwordx4 v16, s[20:23], s45 offen offset:2048 lds
    s_waitcnt vmcnt(7)
    s_waitcnt lgkmcnt(0)
    s_barrier
    ds_read_b64_tr_b16 a[0:1], v10 offset:0
    ds_read_b64_tr_b16 a[2:3], v10 offset:2048
    ds_read_b64_tr_b16 a[4:5], v11 offset:0
    ds_read_b64_tr_b16 a[6:7], v11 offset:2048
    ds_read_b128 a[64:67], v8 offset:0
    ds_read_b64_tr_b16 a[8:9], v10 offset:1024
    ds_read_b64_tr_b16 a[10:11], v10 offset:3072
    ds_read_b64_tr_b16 a[12:13], v11 offset:1024
    ds_read_b64_tr_b16 a[14:15], v11 offset:3072
    ds_read_b128 a[68:71], v8 offset:2048
    ds_read_b128 a[72:75], v8 offset:4096
    ds_read_b128 a[76:79], v8 offset:6144
    s_waitcnt lgkmcnt(2)
    v_mfma_f32_16x16x32_bf16 v[64:67], a[0:3], a[64:67], 0
    ds_read_b128 a[80:83], v8 offset:8192
    s_add_u32 s57, s57, 1
    v_mfma_f32_16x16x32_bf16 v[68:71], a[4:7], a[64:67], 0
    s_cmp_eq_u32 s57, 6
    s_cselect_b32 s57, 0, s57
    v_mfma_f32_16x16x32_bf16 v[76:79], a[12:15], a[64:67], 0
    s_cmp_ge_u32 s57, s42
    s_addc_u32 s49, s57, 0
    v_mfma_f32_16x16x32_bf16 v[72:75], a[8:11], a[64:67], 0
    buffer_load_dwordx4 v17, s[20:23], s45 offen offset:3072 lds
    v_mfma_f32_16x16x32_bf16 v[88:91], a[8:11], a[68:71], 0
    s_add_u32 m0, s52, 20480
    ds_read_b128 a[84:87], v8 offset:10240
    v_mfma_f32_16x16x32_bf16 v[92:95], a[12:15], a[68:71], 0
    s_lshl_b32 s46, s61, 7
    s_lshl_b32 s49, s49, 12
    v_mfma_f32_16x16x32_bf16 v[84:87], a[4:7], a[68:71], 0
    buffer_load_dwordx4 v1, s[4:7], s46 offen offset:0 lds
    v_mfma_f32_16x16x32_bf16 v[80:83], a[0:3], a[68:71], 0
    s_add_u32 s72, s49, s48
    s_waitcnt lgkmcnt(2)
    v_mfma_f32_16x16x32_bf16 v[96:99], a[0:3], a[72:75], 0
    ds_read_b128 a[88:91], v8 offset:12288
    s_add_u32 s56, s56, s42
    v_mfma_f32_16x16x32_bf16 v[100:103], a[4:7], a[72:75], 0
    buffer_load_dwordx4 v2, s[4:7], s46 offen offset:1024 lds
    v_mfma_f32_16x16x32_bf16 v[108:111], a[12:15], a[72:75], 0
    s_add_u32 s49, s56, 0
    s_and_b32 s49, s49, 3
    v_mfma_f32_16x16x32_bf16 v[104:107], a[8:11], a[72:75], 0
    s_lshl2_add_u32 s49, s40, s49
    s_lshl_b32 s73, s49, 10
    v_mfma_f32_16x16x32_bf16 v[120:123], a[8:11], a[76:79], 0
    buffer_load_dwordx4 v3, s[4:7], s46 offen offset:2048 lds
    v_mfma_f32_16x16x32_bf16 v[124:127], a[12:15], a[76:79], 0
    ds_read_b128 a[92:95], v8 offset:14336
    s_add_u32 s49, s56, 1
    v_mfma_f32_16x16x32_bf16 v[116:119], a[4:7], a[76:79], 0
    s_and_b32 s49, s49, 3
    s_lshl2_add_u32 s49, s40, s49
    v_mfma_f32_16x16x32_bf16 v[112:115], a[0:3], a[76:79], 0
    s_lshl_b32 s74, s49, 10
    s_waitcnt lgkmcnt(2)
    v_mfma_f32_16x16x32_bf16 v[128:131], a[0:3], a[80:83], 0
    buffer_load_dwordx4 v4, s[4:7], s46 offen offset:3072 lds
    v_mfma_f32_16x16x32_bf16 v[132:135], a[4:7], a[80:83], 0
    s_add_u32 m0, s52, 24576
    ds_read_b128 a[64:67], v8 offset:16384
    v_mfma_f32_16x16x32_bf16 v[140:143], a[12:15], a[80:83], 0
    s_nop 0
    s_add_u32 s49, s56, 2
    v_mfma_f32_16x16x32_bf16 v[136:139], a[8:11], a[80:83], 0
    buffer_load_dwordx4 v5, s[4:7], s46 offen offset:0 lds
    v_mfma_f32_16x16x32_bf16 v[152:155], a[8:11], a[84:87], 0
    s_add_u32 m0, s53, 94208
    ds_read_b128 a[68:71], v8 offset:18432
    v_mfma_f32_16x16x32_bf16 v[156:159], a[12:15], a[84:87], 0
    s_mul_i32 s47, s61, 229376
    s_and_b32 s49, s49, 3
    v_mfma_f32_16x16x32_bf16 v[148:151], a[4:7], a[84:87], 0
    buffer_load_dwordx4 v6, s[8:11], s47 offen offset:0 lds
    v_mfma_f32_16x16x32_bf16 v[144:147], a[0:3], a[84:87], 0
    s_waitcnt vmcnt(10)
    s_barrier
    s_waitcnt lgkmcnt(2)
    v_mfma_f32_16x16x32_bf16 v[160:163], a[0:3], a[88:91], 0
    buffer_load_dwordx4 v6, s[12:15], s47 offen offset:1024 lds
    v_mfma_f32_16x16x32_bf16 v[164:167], a[4:7], a[88:91], 0
    ds_read_b128 a[72:75], v9 offset:0
    ds_read_b64_tr_b16 a[16:17], v10 offset:16384
    v_mfma_f32_16x16x32_bf16 v[172:175], a[12:15], a[88:91], 0
    ds_read_b64_tr_b16 a[18:19], v10 offset:18432
    ds_read_b64_tr_b16 a[20:21], v11 offset:16384
    v_mfma_f32_16x16x32_bf16 v[168:171], a[8:11], a[88:91], 0
    buffer_load_dwordx4 v7, s[8:11], s47 offen offset:2048 lds
    v_mfma_f32_16x16x32_bf16 v[184:187], a[8:11], a[92:95], 0
    ds_read_b128 a[76:79], v9 offset:2048
    ds_read_b64_tr_b16 a[22:23], v11 offset:18432
    v_mfma_f32_16x16x32_bf16 v[188:191], a[12:15], a[92:95], 0
    ds_read_b64_tr_b16 a[24:25], v10 offset:17408
    ds_read_b64_tr_b16 a[26:27], v10 offset:19456
    v_mfma_f32_16x16x32_bf16 v[180:183], a[4:7], a[92:95], 0
    buffer_load_dwordx4 v7, s[12:15], s47 offen offset:3072 lds
    v_mfma_f32_16x16x32_bf16 v[176:179], a[0:3], a[92:95], 0
    s_add_u32 m0, s53, 143360
    s_waitcnt vmcnt(9)
    s_waitcnt lgkmcnt(8)
    v_mfma_f32_16x16x32_bf16 v[192:195], a[0:3], a[64:67], 0
    s_mul_i32 s45, s68, 28
    ds_read_b128 a[80:83], v9 offset:4096
    v_mfma_f32_16x16x32_bf16 v[196:199], a[4:7], a[64:67], 0
    buffer_load_dwordx4 v14, s[20:23], s45 offen offset:0 lds
    v_mfma_f32_16x16x32_bf16 v[204:207], a[12:15], a[64:67], 0
    ds_read_b64_tr_b16 a[28:29], v11 offset:17408
    ds_read_b64_tr_b16 a[30:31], v11 offset:19456
    v_mfma_f32_16x16x32_bf16 v[200:203], a[8:11], a[64:67], 0
    ds_read_b64_tr_b16 a[96:97], v34 offset:49152
    ds_read_b64_tr_b16 a[98:99], v34 offset:51200
    v_mfma_f32_16x16x32_bf16 v[216:219], a[8:11], a[68:71], 0
    buffer_load_dwordx4 v15, s[20:23], s45 offen offset:1024 lds
    v_mfma_f32_16x16x32_bf16 v[220:223], a[12:15], a[68:71], 0
    ds_read_b128 a[84:87], v9 offset:6144
    ds_read_b64_tr_b16 a[100:101], v35 offset:49152
    v_mfma_f32_16x16x32_bf16 v[212:215], a[4:7], a[68:71], 0
    ds_read_b64_tr_b16 a[102:103], v35 offset:51200
    ds_read_b64_tr_b16 a[104:105], v36 offset:49152
    v_mfma_f32_16x16x32_bf16 v[208:211], a[0:3], a[68:71], 0
    ds_read_b64_tr_b16 a[106:107], v36 offset:51200
    s_waitcnt lgkmcnt(7)
    v_mfma_f32_16x16x32_bf16 v[64:67], a[16:19], a[72:75], v[64:67]
    buffer_load_dwordx4 v16, s[20:23], s45 offen offset:2048 lds
    v_mfma_f32_16x16x32_bf16 v[68:71], a[20:23], a[72:75], v[68:71]
    ds_read_b128 a[88:91], v9 offset:8192
    ds_read_b64_tr_b16 a[108:109], v37 offset:49152
    v_mfma_f32_16x16x32_bf16 v[76:79], a[28:31], a[72:75], v[76:79]
    ds_read_b64_tr_b16 a[110:111], v37 offset:51200
    s_lshl2_add_u32 s49, s40, s49
    v_mfma_f32_16x16x32_bf16 v[72:75], a[24:27], a[72:75], v[72:75]
    buffer_load_dwordx4 v17, s[20:23], s45 offen offset:3072 lds
    v_mfma_f32_16x16x32_bf16 v[88:91], a[24:27], a[76:79], v[88:91]
    s_add_u32 m0, s53, 110592
    ds_read_b128 a[92:95], v9 offset:10240
    v_mfma_f32_16x16x32_bf16 v[92:95], a[28:31], a[76:79], v[92:95]
    s_add_u32 s47, s47, 114688
    s_lshl_b32 s75, s49, 10
    v_mfma_f32_16x16x32_bf16 v[84:87], a[20:23], a[76:79], v[84:87]
    buffer_load_dwordx4 v6, s[8:11], s47 offen offset:0 lds
    v_mfma_f32_16x16x32_bf16 v[80:83], a[16:19], a[76:79], v[80:83]
    s_add_u32 s49, s56, 3
    s_waitcnt lgkmcnt(8)
    v_mfma_f32_16x16x32_bf16 v[96:99], a[16:19], a[80:83], v[96:99]
    ds_read_b128 a[64:67], v9 offset:12288
    s_and_b32 s49, s49, 3
    v_mfma_f32_16x16x32_bf16 v[100:103], a[20:23], a[80:83], v[100:103]
    buffer_load_dwordx4 v6, s[12:15], s47 offen offset:1024 lds
    v_mfma_f32_16x16x32_bf16 v[108:111], a[28:31], a[80:83], v[108:111]
    s_lshl2_add_u32 s49, s40, s49
    s_lshl_b32 s76, s49, 10
    v_mfma_f32_16x16x32_bf16 v[104:107], a[24:27], a[80:83], v[104:107]
    v_lshlrev_b32 v47, 4, v0
    v_lshlrev_b32 v247, 3, v0
    v_mfma_f32_16x16x32_bf16 v[120:123], a[24:27], a[84:87], v[120:123]
    buffer_load_dwordx4 v7, s[8:11], s47 offen offset:2048 lds
    v_mfma_f32_16x16x32_bf16 v[124:127], a[28:31], a[84:87], v[124:127]
    ds_read_b128 a[68:71], v9 offset:14336
    s_mul_i32 s54, s41, 57344
    v_mfma_f32_16x16x32_bf16 v[116:119], a[20:23], a[84:87], v[116:119]
    s_add_u32 s54, s54, s3
    s_mul_i32 s54, s54, 3
    v_mfma_f32_16x16x32_bf16 v[112:115], a[16:19], a[84:87], v[112:115]
    s_add_u32 s54, s54, 16777216
    s_waitcnt lgkmcnt(2)
    v_mfma_f32_16x16x32_bf16 v[128:131], a[16:19], a[88:91], v[128:131]
    buffer_load_dwordx4 v7, s[12:15], s47 offen offset:3072 lds
    v_mfma_f32_16x16x32_bf16 v[132:135], a[20:23], a[88:91], v[132:135]
    s_add_u32 m0, s52, 40960
    ds_read_b128 a[72:75], v9 offset:16384
    v_mfma_f32_16x16x32_bf16 v[140:143], a[28:31], a[88:91], v[140:143]
    s_lshl_b32 s46, s62, 7
    s_mul_i32 s49, s43, 172032
    v_mfma_f32_16x16x32_bf16 v[136:139], a[24:27], a[88:91], v[136:139]
    buffer_load_dwordx4 v1, s[4:7], s46 offen offset:0 lds
    v_mfma_f32_16x16x32_bf16 v[152:155], a[24:27], a[92:95], v[152:155]
    ds_read_b128 a[76:79], v9 offset:18432
    s_sub_u32 s58, s54, s49
    v_mfma_f32_16x16x32_bf16 v[156:159], a[28:31], a[92:95], v[156:159]
    buffer_load_dwordx4 v2, s[4:7], s46 offen offset:1024 lds
    v_mfma_f32_16x16x32_bf16 v[148:151], a[20:23], a[92:95], v[148:151]
    s_add_u32 s58, s58, 86016
    v_mov_b32 v248, -1
    v_mfma_f32_16x16x32_bf16 v[144:147], a[16:19], a[92:95], v[144:147]
    s_waitcnt vmcnt(10)
    s_barrier
    s_waitcnt lgkmcnt(2)
    v_mfma_f32_16x16x32_bf16 v[160:163], a[16:19], a[64:67], v[160:163]
    buffer_load_dwordx4 v3, s[4:7], s46 offen offset:2048 lds
    v_mfma_f32_16x16x32_bf16 v[164:167], a[20:23], a[64:67], v[164:167]
    ds_read_b128 a[80:83], v8 offset:20480
    ds_read_b64_tr_b16 a[0:1], v10 offset:32768
    v_mfma_f32_16x16x32_bf16 v[172:175], a[28:31], a[64:67], v[172:175]
L_pad_ffn_0:
    s_cbranch_execz L_ret_ffn
    ds_read_b64_tr_b16 a[2:3], v10 offset:34816
    ds_read_b64_tr_b16 a[4:5], v11 offset:32768
    v_mfma_f32_16x16x32_bf16 v[168:171], a[24:27], a[64:67], v[168:171]
    buffer_load_dwordx4 v4, s[4:7], s46 offen offset:3072 lds
    v_mfma_f32_16x16x32_bf16 v[184:187], a[24:27], a[68:71], v[184:187]
    s_add_u32 m0, s52, 45056
    ds_read_b128 a[84:87], v8 offset:22528
    v_mfma_f32_16x16x32_bf16 v[188:191], a[28:31], a[68:71], v[188:191]
    s_nop 0
    ds_read_b64_tr_b16 a[6:7], v11 offset:34816
    v_mfma_f32_16x16x32_bf16 v[180:183], a[20:23], a[68:71], v[180:183]
    buffer_load_dwordx4 v5, s[4:7], s46 offen offset:0 lds
    v_mfma_f32_16x16x32_bf16 v[176:179], a[16:19], a[68:71], v[176:179]
    s_add_u32 m0, s53, 126976
    s_waitcnt vmcnt(9)
    s_waitcnt lgkmcnt(6)
    v_mfma_f32_16x16x32_bf16 v[192:195], a[16:19], a[72:75], v[192:195]
    s_mul_i32 s47, s62, 229376
    ds_read_b128 a[88:91], v8 offset:24576
    v_mfma_f32_16x16x32_bf16 v[196:199], a[20:23], a[72:75], v[196:199]
    buffer_load_dwordx4 v6, s[8:11], s47 offen offset:0 lds
    v_mfma_f32_16x16x32_bf16 v[204:207], a[28:31], a[72:75], v[204:207]
    ds_read_b64_tr_b16 a[8:9], v10 offset:33792
    ds_read_b64_tr_b16 a[10:11], v10 offset:35840
    v_mfma_f32_16x16x32_bf16 v[200:203], a[24:27], a[72:75], v[200:203]
    ds_read_b64_tr_b16 a[12:13], v11 offset:33792
    ds_read_b64_tr_b16 a[14:15], v11 offset:35840
    v_mfma_f32_16x16x32_bf16 v[216:219], a[24:27], a[76:79], v[216:219]
    ds_read_b128 a[92:95], v8 offset:26624
    ds_read_b64_tr_b16 a[112:113], v38 offset:0
    v_mfma_f32_16x16x32_bf16 v[220:223], a[28:31], a[76:79], v[220:223]
    buffer_load_dwordx4 v6, s[12:15], s47 offen offset:1024 lds
    v_mfma_f32_16x16x32_bf16 v[212:215], a[20:23], a[76:79], v[212:215]
    ds_read_b64_tr_b16 a[114:115], v38 offset:2048
    ds_read_b64_tr_b16 a[116:117], v39 offset:0
    v_mfma_f32_16x16x32_bf16 v[208:211], a[16:19], a[76:79], v[208:211]
    ds_read_b64_tr_b16 a[118:119], v39 offset:2048
    s_waitcnt lgkmcnt(5)
    v_mfma_f32_16x16x32_bf16 v[64:67], a[0:3], a[80:83], v[64:67]
    buffer_load_dwordx4 v7, s[8:11], s47 offen offset:2048 lds
    v_mfma_f32_16x16x32_bf16 v[68:71], a[4:7], a[80:83], v[68:71]
    ds_read_b128 a[64:67], v8 offset:28672
    ds_read_b64_tr_b16 a[120:121], v40 offset:0
    v_mfma_f32_16x16x32_bf16 v[76:79], a[12:15], a[80:83], v[76:79]
    ds_read_b64_tr_b16 a[122:123], v40 offset:2048
    ds_read_b64_tr_b16 a[124:125], v41 offset:0
    v_mfma_f32_16x16x32_bf16 v[72:75], a[8:11], a[80:83], v[72:75]
    buffer_load_dwordx4 v7, s[12:15], s47 offen offset:3072 lds
    v_mfma_f32_16x16x32_bf16 v[88:91], a[8:11], a[84:87], v[88:91]
    s_add_u32 m0, s53, 61440
    ds_read_b128 a[68:71], v8 offset:30720
    v_mfma_f32_16x16x32_bf16 v[92:95], a[12:15], a[84:87], v[92:95]
    s_add_u32 s47, s47, 114688
    ds_read_b64_tr_b16 a[126:127], v41 offset:2048
    v_mfma_f32_16x16x32_bf16 v[84:87], a[4:7], a[84:87], v[84:87]
    buffer_load_dwordx4 v6, s[8:11], s47 offen offset:0 lds
    v_mfma_f32_16x16x32_bf16 v[80:83], a[0:3], a[84:87], v[80:83]
    v_mov_b32 v249, -1
    s_waitcnt lgkmcnt(10)
    v_mfma_f32_16x16x32_bf16 v[96:99], a[0:3], a[88:91], v[96:99]
    ds_read_b128 a[72:75], v8 offset:32768
    v_mov_b32 v250, -1
    v_mfma_f32_16x16x32_bf16 v[100:103], a[4:7], a[88:91], v[100:103]
    buffer_load_dwordx4 v6, s[12:15], s47 offen offset:1024 lds
    v_mfma_f32_16x16x32_bf16 v[108:111], a[12:15], a[88:91], v[108:111]
    v_mov_b32 v251, -1
    s_lshl1_add_u32 s48, s41, s43
    v_mfma_f32_16x16x32_bf16 v[104:107], a[8:11], a[88:91], v[104:107]
    s_xor_b32 s49, s48, 1
    s_mul_i32 s49, s49, 368640
    v_mfma_f32_16x16x32_bf16 v[120:123], a[8:11], a[92:95], v[120:123]
    buffer_load_dwordx4 v7, s[8:11], s47 offen offset:2048 lds
    v_mfma_f32_16x16x32_bf16 v[124:127], a[12:15], a[92:95], v[124:127]
    ds_read_b128 a[76:79], v8 offset:34816
    v_add_u32 v42, s49, v47
    v_mfma_f32_16x16x32_bf16 v[116:119], a[4:7], a[92:95], v[116:119]
    v_add_u32 v43, 73728, v42
    v_add_u32 v44, 147456, v42
    v_mfma_f32_16x16x32_bf16 v[112:115], a[0:3], a[92:95], v[112:115]
    v_add_u32 v45, 221184, v42
    s_waitcnt lgkmcnt(3)
    v_mfma_f32_16x16x32_bf16 v[128:131], a[0:3], a[64:67], v[128:131]
    buffer_load_dwordx4 v7, s[12:15], s47 offen offset:3072 lds
    v_mfma_f32_16x16x32_bf16 v[132:135], a[4:7], a[64:67], v[132:135]
    s_add_u32 m0, s53, 77824
    ds_read_b128 a[80:83], v8 offset:36864
    v_mfma_f32_16x16x32_bf16 v[140:143], a[12:15], a[64:67], v[140:143]
    s_mul_i32 s47, s63, 229376
    v_add_u32 v46, 294912, v42
    v_mfma_f32_16x16x32_bf16 v[136:139], a[8:11], a[64:67], v[136:139]
    buffer_load_dwordx4 v6, s[8:11], s47 offen offset:0 lds
    v_mfma_f32_16x16x32_bf16 v[152:155], a[8:11], a[68:71], v[152:155]
    ds_read_b128 a[84:87], v8 offset:38912
    s_xor_b32 s49, s48, 0
    v_mfma_f32_16x16x32_bf16 v[156:159], a[12:15], a[68:71], v[156:159]
    buffer_load_dwordx4 v6, s[12:15], s47 offen offset:1024 lds
    v_mfma_f32_16x16x32_bf16 v[148:151], a[4:7], a[68:71], v[148:151]
    s_mul_i32 s49, s49, 368640
    v_add_u32 v240, s49, v47
    v_mfma_f32_16x16x32_bf16 v[144:147], a[0:3], a[68:71], v[144:147]
    s_waitcnt vmcnt(15)
    s_barrier
    s_waitcnt lgkmcnt(2)
    v_mfma_f32_16x16x32_bf16 v[160:163], a[0:3], a[72:75], v[160:163]
    buffer_load_dwordx4 v7, s[8:11], s47 offen offset:2048 lds
    v_mfma_f32_16x16x32_bf16 v[164:167], a[4:7], a[72:75], v[164:167]
    ds_read_b128 a[88:91], v9 offset:20480
    ds_read_b64_tr_b16 a[16:17], v10 offset:49152
    v_mfma_f32_16x16x32_bf16 v[172:175], a[12:15], a[72:75], v[172:175]
    ds_read_b64_tr_b16 a[18:19], v10 offset:51200
    ds_read_b64_tr_b16 a[20:21], v11 offset:49152
    v_mfma_f32_16x16x32_bf16 v[168:171], a[8:11], a[72:75], v[168:171]
    buffer_load_dwordx4 v7, s[12:15], s47 offen offset:3072 lds
    v_mfma_f32_16x16x32_bf16 v[184:187], a[8:11], a[76:79], v[184:187]
    s_add_u32 m0, s53, 143360
    ds_read_b128 a[92:95], v9 offset:22528
    v_mfma_f32_16x16x32_bf16 v[188:191], a[12:15], a[76:79], v[188:191]
    s_mul_i32 s45, s73, 49
    ds_read_b64_tr_b16 a[22:23], v11 offset:51200
    v_mfma_f32_16x16x32_bf16 v[180:183], a[4:7], a[76:79], v[180:183]
    s_lshr_b32 s45, s45, 1
    ds_read_b64_tr_b16 a[24:25], v10 offset:50176
    v_mfma_f32_16x16x32_bf16 v[176:179], a[0:3], a[76:79], v[176:179]
    s_add_u32 s73, s73, 57344
    s_waitcnt lgkmcnt(7)
    v_mfma_f32_16x16x32_bf16 v[192:195], a[0:3], a[80:83], v[192:195]
    buffer_load_dwordx4 v14, s[24:27], s45 offen offset:0 lds
    v_mfma_f32_16x16x32_bf16 v[196:199], a[4:7], a[80:83], v[196:199]
    ds_read_b128 a[64:67], v9 offset:24576
    ds_read_b64_tr_b16 a[26:27], v10 offset:52224
    v_mfma_f32_16x16x32_bf16 v[204:207], a[12:15], a[80:83], v[204:207]
    buffer_load_dwordx4 v18, s[24:27], s45 offen offset:1024 lds
    v_mfma_f32_16x16x32_bf16 v[200:203], a[8:11], a[80:83], v[200:203]
    ds_read_b64_tr_b16 a[28:29], v11 offset:50176
    ds_read_b64_tr_b16 a[30:31], v11 offset:52224
    v_mfma_f32_16x16x32_bf16 v[216:219], a[8:11], a[84:87], v[216:219]
    ds_read_b128 a[68:71], v9 offset:26624
    v_add_u32 v241, 73728, v240
    v_mfma_f32_16x16x32_bf16 v[220:223], a[12:15], a[84:87], v[220:223]
    buffer_load_dwordx4 v19, s[24:27], s45 offen offset:2048 lds
    v_mfma_f32_16x16x32_bf16 v[212:215], a[4:7], a[84:87], v[212:215]
    v_add_u32 v242, 147456, v240
    v_add_u32 v243, 221184, v240
    v_mfma_f32_16x16x32_bf16 v[208:211], a[0:3], a[84:87], v[208:211]
    v_add_u32 v244, 294912, v240
    s_waitcnt lgkmcnt(1)
    v_mfma_f32_16x16x32_bf16 v[64:67], a[16:19], a[88:91], v[64:67]
    buffer_load_dwordx4 v17, s[24:27], s45 offen offset:3072 lds
    v_mfma_f32_16x16x32_bf16 v[68:71], a[20:23], a[88:91], v[68:71]
    s_add_u32 m0, s52, 0
    ds_read_b128 a[72:75], v9 offset:28672
    v_mfma_f32_16x16x32_bf16 v[76:79], a[28:31], a[88:91], v[76:79]
    s_lshl_b32 s46, s63, 7
    s_mul_i32 s48, s48, 80
    v_mfma_f32_16x16x32_bf16 v[72:75], a[24:27], a[88:91], v[72:75]
    buffer_load_dwordx4 v1, s[4:7], s46 offen offset:0 lds
    v_mfma_f32_16x16x32_bf16 v[88:91], a[24:27], a[92:95], v[88:91]
    ds_read_b128 a[76:79], v9 offset:30720
    s_lshr_b32 s49, s48, 6
    v_mfma_f32_16x16x32_bf16 v[92:95], a[28:31], a[92:95], v[92:95]
    v_and_b32 v27, 1, v0
    v_add_u32 v27, s49, v27
    v_mfma_f32_16x16x32_bf16 v[84:87], a[20:23], a[92:95], v[84:87]
    buffer_load_dwordx4 v2, s[4:7], s46 offen offset:1024 lds
    v_mfma_f32_16x16x32_bf16 v[80:83], a[16:19], a[92:95], v[80:83]
    v_min_u32 v27, 31, v27
    s_waitcnt lgkmcnt(2)
    v_mfma_f32_16x16x32_bf16 v[96:99], a[16:19], a[64:67], v[96:99]
    ds_read_b128 a[80:83], v9 offset:32768
    v_bfe_u32 v28, v0, 1, 1
    v_mfma_f32_16x16x32_bf16 v[100:103], a[20:23], a[64:67], v[100:103]
    buffer_load_dwordx4 v3, s[4:7], s46 offen offset:2048 lds
    v_mfma_f32_16x16x32_bf16 v[108:111], a[28:31], a[64:67], v[108:111]
    s_lshl_b32 s49, s40, 1
    v_add_u32 v28, s49, v28
    v_mfma_f32_16x16x32_bf16 v[104:107], a[24:27], a[64:67], v[104:107]
    v_lshl_add_u32 v27, v28, 5, v27
    v_lshlrev_b32 v27, 7, v27
    v_mfma_f32_16x16x32_bf16 v[120:123], a[24:27], a[68:71], v[120:123]
    buffer_load_dwordx4 v4, s[4:7], s46 offen offset:3072 lds
    v_mfma_f32_16x16x32_bf16 v[124:127], a[28:31], a[68:71], v[124:127]
    s_add_u32 m0, s52, 4096
    ds_read_b128 a[84:87], v9 offset:34816
    v_mfma_f32_16x16x32_bf16 v[116:119], a[20:23], a[68:71], v[116:119]
    s_nop 0
    v_add_u32 v52, 11819008, v27
    v_mfma_f32_16x16x32_bf16 v[112:115], a[16:19], a[68:71], v[112:115]
    s_mul_i32 s79, s48, 7
    s_waitcnt lgkmcnt(2)
    v_mfma_f32_16x16x32_bf16 v[128:131], a[16:19], a[72:75], v[128:131]
    buffer_load_dwordx4 v5, s[4:7], s46 offen offset:0 lds
    v_mfma_f32_16x16x32_bf16 v[132:135], a[20:23], a[72:75], v[132:135]
    s_add_u32 m0, s53, 94208
    ds_read_b128 a[88:91], v9 offset:36864
    v_mfma_f32_16x16x32_bf16 v[140:143], a[28:31], a[72:75], v[140:143]
    s_add_u32 s47, s47, 114688
    s_add_u32 s79, s79, s42
    v_mfma_f32_16x16x32_bf16 v[136:139], a[24:27], a[72:75], v[136:139]
    buffer_load_dwordx4 v6, s[8:11], s47 offen offset:0 lds
    v_mfma_f32_16x16x32_bf16 v[152:155], a[24:27], a[76:79], v[152:155]
    ds_read_b128 a[92:95], v9 offset:38912
    s_lshl_b32 s79, s79, 7
    v_mfma_f32_16x16x32_bf16 v[156:159], a[28:31], a[76:79], v[156:159]
    s_lshl1_add_u32 s50, s41, s43
    s_lshl_b32 s50, s50, 9
    v_mfma_f32_16x16x32_bf16 v[148:151], a[20:23], a[76:79], v[148:151]
    buffer_load_dwordx4 v6, s[12:15], s47 offen offset:1024 lds
    v_mfma_f32_16x16x32_bf16 v[144:147], a[16:19], a[76:79], v[144:147]
    s_waitcnt vmcnt(19)
    s_barrier
    s_waitcnt lgkmcnt(2)
    v_mfma_f32_16x16x32_bf16 v[160:163], a[16:19], a[80:83], v[160:163]
    ds_read_b128 a[64:67], v8 offset:40960
    ds_read_b64_tr_b16 a[0:1], v12 offset:0
    v_mfma_f32_16x16x32_bf16 v[164:167], a[20:23], a[80:83], v[164:167]
    buffer_load_dwordx4 v7, s[8:11], s47 offen offset:2048 lds
    v_mfma_f32_16x16x32_bf16 v[172:175], a[28:31], a[80:83], v[172:175]
    ds_read_b64_tr_b16 a[2:3], v12 offset:2048
    ds_read_b64_tr_b16 a[4:5], v13 offset:0
    v_mfma_f32_16x16x32_bf16 v[168:171], a[24:27], a[80:83], v[168:171]
    ds_read_b64_tr_b16 a[6:7], v13 offset:2048
    ds_read_b64_tr_b16 a[8:9], v12 offset:1024
    v_mfma_f32_16x16x32_bf16 v[184:187], a[24:27], a[84:87], v[184:187]
    buffer_load_dwordx4 v7, s[12:15], s47 offen offset:3072 lds
    v_mfma_f32_16x16x32_bf16 v[188:191], a[28:31], a[84:87], v[188:191]
    s_add_u32 m0, s53, 110592
    ds_read_b128 a[68:71], v8 offset:43008
    v_mfma_f32_16x16x32_bf16 v[180:183], a[20:23], a[84:87], v[180:183]
    s_mul_i32 s47, s64, 229376
    ds_read_b64_tr_b16 a[10:11], v12 offset:3072
    v_mfma_f32_16x16x32_bf16 v[176:179], a[16:19], a[84:87], v[176:179]
    ds_read_b64_tr_b16 a[12:13], v13 offset:1024
    s_waitcnt vmcnt(9)
    s_waitcnt lgkmcnt(9)
    v_mfma_f32_16x16x32_bf16 v[192:195], a[16:19], a[88:91], v[192:195]
    buffer_load_dwordx4 v6, s[8:11], s47 offen offset:0 lds
    v_mfma_f32_16x16x32_bf16 v[196:199], a[20:23], a[88:91], v[196:199]
    ds_read_b128 a[72:75], v8 offset:45056
    ds_read_b64_tr_b16 a[14:15], v13 offset:3072
    v_mfma_f32_16x16x32_bf16 v[204:207], a[28:31], a[88:91], v[204:207]
    buffer_load_dwordx4 v6, s[12:15], s47 offen offset:1024 lds
    v_mfma_f32_16x16x32_bf16 v[200:203], a[24:27], a[88:91], v[200:203]
    ds_read_b64_tr_b16 a[128:129], v38 offset:0
    ds_read_b64_tr_b16 a[130:131], v38 offset:2048
    v_mfma_f32_16x16x32_bf16 v[216:219], a[24:27], a[92:95], v[216:219]
    ds_read_b128 a[76:79], v8 offset:47104
    ds_read_b64_tr_b16 a[132:133], v39 offset:0
    v_mfma_f32_16x16x32_bf16 v[220:223], a[28:31], a[92:95], v[220:223]
    buffer_load_dwordx4 v7, s[8:11], s47 offen offset:2048 lds
    v_mfma_f32_16x16x32_bf16 v[212:215], a[20:23], a[92:95], v[212:215]
    ds_read_b64_tr_b16 a[134:135], v39 offset:2048
    ds_read_b64_tr_b16 a[136:137], v40 offset:0
    v_mfma_f32_16x16x32_bf16 v[208:211], a[16:19], a[92:95], v[208:211]
    ds_read_b64_tr_b16 a[138:139], v40 offset:2048
    s_waitcnt lgkmcnt(7)
    v_mfma_f32_16x16x32_bf16 v[64:67], a[0:3], a[64:67], v[64:67]
    buffer_load_dwordx4 v7, s[12:15], s47 offen offset:3072 lds
    v_mfma_f32_16x16x32_bf16 v[68:71], a[4:7], a[64:67], v[68:71]
    ds_read_b128 a[80:83], v8 offset:49152
    ds_read_b64_tr_b16 a[140:141], v41 offset:0
    v_mfma_f32_16x16x32_bf16 v[76:79], a[12:15], a[64:67], v[76:79]
    ds_read_b64_tr_b16 a[142:143], v41 offset:2048
    s_add_u32 s49, s50, 11534336
    v_mfma_f32_16x16x32_bf16 v[72:75], a[8:11], a[64:67], v[72:75]
    v_and_b32 v27, 15, v0
    v_lshl_add_u32 v59, v27, 5, s49
    v_mfma_f32_16x16x32_bf16 v[88:91], a[8:11], a[68:71], v[88:91]
    ds_read_b128 a[84:87], v8 offset:51200
    v_mfma_f32_16x16x32_bf16 v[92:95], a[12:15], a[68:71], v[92:95]
    s_cmp_eq_u32 s50, 12800
    s_cselect_b32 s50, 0, 12
    v_mfma_f32_16x16x32_bf16 v[84:87], a[4:7], a[68:71], v[84:87]
    v_add_u32 v252, s50, v59
    s_mul_i32 s48, s41, 7168
    v_mfma_f32_16x16x32_bf16 v[80:83], a[0:3], a[68:71], v[80:83]
    s_lshr_b32 s59, s3, 3
    s_waitcnt lgkmcnt(8)
    v_mfma_f32_16x16x32_bf16 v[96:99], a[0:3], a[72:75], v[96:99]
    ds_read_b128 a[88:91], v8 offset:53248
    s_add_u32 s59, s59, s48
    v_mfma_f32_16x16x32_bf16 v[100:103], a[4:7], a[72:75], v[100:103]
    s_add_u32 s59, s59, 11599872
    s_lshl_b32 s49, s40, 7
    v_mfma_f32_16x16x32_bf16 v[108:111], a[12:15], a[72:75], v[108:111]
    s_add_u32 s48, s48, s49
    v_min_u32 v27, 6, v0
    v_mfma_f32_16x16x32_bf16 v[104:107], a[8:11], a[72:75], v[104:107]
    v_lshl_add_u32 v27, v27, 9, s48
    s_mul_i32 s49, s43, 3584
    v_mfma_f32_16x16x32_bf16 v[120:123], a[8:11], a[76:79], v[120:123]
    ds_read_b128 a[92:95], v8 offset:55296
    s_add_u32 s48, s49, 11693056
    v_mfma_f32_16x16x32_bf16 v[124:127], a[12:15], a[76:79], v[124:127]
    v_add_u32 v51, s48, v27
    v_subrev_u32 v50, 93184, v51
    v_mfma_f32_16x16x32_bf16 v[116:119], a[4:7], a[76:79], v[116:119]
    s_lshl_b32 s49, s49, 1
    s_sub_u32 s48, s59, s49
    v_mfma_f32_16x16x32_bf16 v[112:115], a[0:3], a[76:79], v[112:115]
    s_add_u32 s48, s48, 3584
    s_waitcnt lgkmcnt(2)
    v_mfma_f32_16x16x32_bf16 v[128:131], a[0:3], a[80:83], v[128:131]
    ds_read_b128 a[64:67], v8 offset:57344
    v_writelane_b32 v50, s48, 7
    v_mfma_f32_16x16x32_bf16 v[132:135], a[4:7], a[80:83], v[132:135]
    v_lshlrev_b32 v49, 2, v0
    v_mov_b32 v54, 1
    v_mfma_f32_16x16x32_bf16 v[140:143], a[12:15], a[80:83], v[140:143]
    v_lshlrev_b32 v55, 2, v26
    v_add_u32 v20, 143360, v8
    v_mfma_f32_16x16x32_bf16 v[136:139], a[8:11], a[80:83], v[136:139]
    v_add_u32 v21, 143360, v9
    v_mfma_f32_16x16x32_bf16 v[152:155], a[8:11], a[84:87], v[152:155]
    s_add_u32 m0, s53, 143360
    ds_read_b128 a[68:71], v8 offset:59392
    v_mfma_f32_16x16x32_bf16 v[156:159], a[12:15], a[84:87], v[156:159]
    s_mul_i32 s45, s74, 49
    v_mfma_f32_16x16x32_bf16 v[148:151], a[4:7], a[84:87], v[148:151]
    s_lshr_b32 s45, s45, 1
    v_mfma_f32_16x16x32_bf16 v[144:147], a[0:3], a[84:87], v[144:147]
    s_barrier
    s_waitcnt lgkmcnt(2)
    v_mfma_f32_16x16x32_bf16 v[160:163], a[0:3], a[88:91], v[160:163]
    s_add_u32 s74, s74, 57344
    ds_read_b128 a[72:75], v9 offset:40960
    v_mfma_f32_16x16x32_bf16 v[164:167], a[4:7], a[88:91], v[164:167]
    buffer_load_dwordx4 v14, s[24:27], s45 offen offset:0 lds
    v_mfma_f32_16x16x32_bf16 v[172:175], a[12:15], a[88:91], v[172:175]
    ds_read_b64_tr_b16 a[16:17], v10 offset:0
    ds_read_b64_tr_b16 a[18:19], v10 offset:2048
    v_mfma_f32_16x16x32_bf16 v[168:171], a[8:11], a[88:91], v[168:171]
    buffer_load_dwordx4 v18, s[24:27], s45 offen offset:1024 lds
    v_mfma_f32_16x16x32_bf16 v[184:187], a[8:11], a[92:95], v[184:187]
    ds_read_b128 a[76:79], v9 offset:43008
    ds_read_b64_tr_b16 a[20:21], v11 offset:0
    v_mfma_f32_16x16x32_bf16 v[188:191], a[12:15], a[92:95], v[188:191]
    ds_read_b64_tr_b16 a[22:23], v11 offset:2048
    ds_read_b64_tr_b16 a[24:25], v10 offset:1024
    v_mfma_f32_16x16x32_bf16 v[180:183], a[4:7], a[92:95], v[180:183]
    buffer_load_dwordx4 v19, s[24:27], s45 offen offset:2048 lds
    v_mfma_f32_16x16x32_bf16 v[176:179], a[0:3], a[92:95], v[176:179]
    ds_read_b64_tr_b16 a[26:27], v10 offset:3072
    s_waitcnt lgkmcnt(8)
    v_mfma_f32_16x16x32_bf16 v[192:195], a[0:3], a[64:67], v[192:195]
    ds_read_b128 a[80:83], v9 offset:45056
    ds_read_b64_tr_b16 a[28:29], v11 offset:1024
    v_mfma_f32_16x16x32_bf16 v[196:199], a[4:7], a[64:67], v[196:199]
    buffer_load_dwordx4 v17, s[24:27], s45 offen offset:3072 lds
    v_mfma_f32_16x16x32_bf16 v[204:207], a[12:15], a[64:67], v[204:207]
    s_add_u32 m0, s52, 20480
    ds_read_b64_tr_b16 a[30:31], v11 offset:3072
    v_mfma_f32_16x16x32_bf16 v[200:203], a[8:11], a[64:67], v[200:203]
    s_lshl_b32 s46, s64, 7
    v_mfma_f32_16x16x32_bf16 v[216:219], a[8:11], a[68:71], v[216:219]
    buffer_load_dwordx4 v1, s[4:7], s46 offen offset:0 lds
    v_mfma_f32_16x16x32_bf16 v[220:223], a[12:15], a[68:71], v[220:223]
    ds_read_b128 a[84:87], v9 offset:47104
    v_mfma_f32_16x16x32_bf16 v[212:215], a[4:7], a[68:71], v[212:215]
    v_mfma_f32_16x16x32_bf16 v[208:211], a[0:3], a[68:71], v[208:211]
    s_waitcnt lgkmcnt(1)
    v_mfma_f32_16x16x32_bf16 v[64:67], a[16:19], a[72:75], v[64:67]
    buffer_load_dwordx4 v2, s[4:7], s46 offen offset:1024 lds
    v_mfma_f32_16x16x32_bf16 v[68:71], a[20:23], a[72:75], v[68:71]
    ds_read_b128 a[88:91], v9 offset:49152
    v_mfma_f32_16x16x32_bf16 v[76:79], a[28:31], a[72:75], v[76:79]
    v_mfma_f32_16x16x32_bf16 v[72:75], a[24:27], a[72:75], v[72:75]
    v_mfma_f32_16x16x32_bf16 v[88:91], a[24:27], a[76:79], v[88:91]
    buffer_load_dwordx4 v3, s[4:7], s46 offen offset:2048 lds
    v_mfma_f32_16x16x32_bf16 v[92:95], a[28:31], a[76:79], v[92:95]
    ds_read_b128 a[92:95], v9 offset:51200
    v_mfma_f32_16x16x32_bf16 v[84:87], a[20:23], a[76:79], v[84:87]
    v_mfma_f32_16x16x32_bf16 v[80:83], a[16:19], a[76:79], v[80:83]
    s_waitcnt lgkmcnt(2)
    v_mfma_f32_16x16x32_bf16 v[96:99], a[16:19], a[80:83], v[96:99]
    ds_read_b128 a[64:67], v9 offset:53248
    v_mfma_f32_16x16x32_bf16 v[100:103], a[20:23], a[80:83], v[100:103]
    buffer_load_dwordx4 v4, s[4:7], s46 offen offset:3072 lds
    v_mfma_f32_16x16x32_bf16 v[108:111], a[28:31], a[80:83], v[108:111]
    s_add_u32 m0, s52, 24576
    v_mfma_f32_16x16x32_bf16 v[104:107], a[24:27], a[80:83], v[104:107]
    s_nop 0
    v_mfma_f32_16x16x32_bf16 v[120:123], a[24:27], a[84:87], v[120:123]
    ds_read_b128 a[68:71], v9 offset:55296
    v_mfma_f32_16x16x32_bf16 v[124:127], a[28:31], a[84:87], v[124:127]
    buffer_load_dwordx4 v5, s[4:7], s46 offen offset:0 lds
    v_mfma_f32_16x16x32_bf16 v[116:119], a[20:23], a[84:87], v[116:119]
    s_add_u32 m0, s53, 126976
    v_mfma_f32_16x16x32_bf16 v[112:115], a[16:19], a[84:87], v[112:115]
    s_add_u32 s47, s47, 114688
    s_waitcnt lgkmcnt(2)
    v_mfma_f32_16x16x32_bf16 v[128:131], a[16:19], a[88:91], v[128:131]
    ds_read_b128 a[72:75], v9 offset:57344
    v_mfma_f32_16x16x32_bf16 v[132:135], a[20:23], a[88:91], v[132:135]
    v_mfma_f32_16x16x32_bf16 v[140:143], a[28:31], a[88:91], v[140:143]
    buffer_load_dwordx4 v6, s[8:11], s47 offen offset:0 lds
    v_mfma_f32_16x16x32_bf16 v[136:139], a[24:27], a[88:91], v[136:139]
    v_mfma_f32_16x16x32_bf16 v[152:155], a[24:27], a[92:95], v[152:155]
    ds_read_b128 a[76:79], v9 offset:59392
    v_mfma_f32_16x16x32_bf16 v[156:159], a[28:31], a[92:95], v[156:159]
    v_mfma_f32_16x16x32_bf16 v[148:151], a[20:23], a[92:95], v[148:151]
    v_mfma_f32_16x16x32_bf16 v[144:147], a[16:19], a[92:95], v[144:147]
    s_waitcnt vmcnt(18)
    s_barrier
    s_waitcnt lgkmcnt(2)
    v_mfma_f32_16x16x32_bf16 v[160:163], a[16:19], a[64:67], v[160:163]
    buffer_load_dwordx4 v6, s[12:15], s47 offen offset:1024 lds
    v_mfma_f32_16x16x32_bf16 v[164:167], a[20:23], a[64:67], v[164:167]
    ds_read_b128 a[80:83], v8 offset:0
    ds_read_b64_tr_b16 a[0:1], v10 offset:16384
    v_mfma_f32_16x16x32_bf16 v[172:175], a[28:31], a[64:67], v[172:175]
    ds_read_b64_tr_b16 a[2:3], v10 offset:18432
    ds_read_b64_tr_b16 a[4:5], v11 offset:16384
    v_mfma_f32_16x16x32_bf16 v[168:171], a[24:27], a[64:67], v[168:171]
    buffer_load_dwordx4 v7, s[8:11], s47 offen offset:2048 lds
    v_mfma_f32_16x16x32_bf16 v[184:187], a[24:27], a[68:71], v[184:187]
    ds_read_b128 a[84:87], v8 offset:2048
    ds_read_b64_tr_b16 a[6:7], v11 offset:18432
    v_mfma_f32_16x16x32_bf16 v[188:191], a[28:31], a[68:71], v[188:191]
    ds_read_b64_tr_b16 a[8:9], v10 offset:17408
    ds_read_b64_tr_b16 a[10:11], v10 offset:19456
    v_mfma_f32_16x16x32_bf16 v[180:183], a[20:23], a[68:71], v[180:183]
    ds_read_b64_tr_b16 a[12:13], v11 offset:17408
    ds_read_b64_tr_b16 a[14:15], v11 offset:19456
    v_mfma_f32_16x16x32_bf16 v[176:179], a[16:19], a[68:71], v[176:179]
    s_waitcnt lgkmcnt(10)
    v_mfma_f32_16x16x32_bf16 v[192:195], a[16:19], a[72:75], v[192:195]
    buffer_load_dwordx4 v7, s[12:15], s47 offen offset:3072 lds
    v_mfma_f32_16x16x32_bf16 v[196:199], a[20:23], a[72:75], v[196:199]
    ds_read_b128 a[88:91], v8 offset:4096
    v_mfma_f32_16x16x32_bf16 v[204:207], a[28:31], a[72:75], v[204:207]
    v_mfma_f32_16x16x32_bf16 v[200:203], a[24:27], a[72:75], v[200:203]
    s_waitcnt vmcnt(9)
    v_mfma_f32_16x16x32_bf16 v[216:219], a[24:27], a[76:79], v[216:219]
    ds_read_b128 a[92:95], v8 offset:6144
    ds_read_b64_tr_b16 a[144:145], v38 offset:0
    v_mfma_f32_16x16x32_bf16 v[220:223], a[28:31], a[76:79], v[220:223]
    buffer_store_dwordx4 v[248:251], v47, s[28:31], s54 offen offset:0 sc1
    v_mfma_f32_16x16x32_bf16 v[212:215], a[20:23], a[76:79], v[212:215]
    ds_read_b64_tr_b16 a[146:147], v38 offset:2048
    ds_read_b64_tr_b16 a[148:149], v39 offset:0
    v_mfma_f32_16x16x32_bf16 v[208:211], a[16:19], a[76:79], v[208:211]
    ds_read_b64_tr_b16 a[150:151], v39 offset:2048
    s_waitcnt lgkmcnt(6)
    v_mfma_f32_16x16x32_bf16 v[64:67], a[0:3], a[80:83], v[64:67]
    ds_read_b128 a[64:67], v8 offset:8192
    ds_read_b64_tr_b16 a[152:153], v40 offset:0
    v_mfma_f32_16x16x32_bf16 v[68:71], a[4:7], a[80:83], v[68:71]
    ds_read_b64_tr_b16 a[154:155], v40 offset:2048
    ds_read_b64_tr_b16 a[156:157], v41 offset:0
    v_mfma_f32_16x16x32_bf16 v[76:79], a[12:15], a[80:83], v[76:79]
    buffer_store_dwordx4 v[248:251], v47, s[28:31], s54 offen offset:1024 sc1
    v_mfma_f32_16x16x32_bf16 v[72:75], a[8:11], a[80:83], v[72:75]
    ds_read_b64_tr_b16 a[158:159], v41 offset:2048
    v_mfma_f32_16x16x32_bf16 v[88:91], a[8:11], a[84:87], v[88:91]
    ds_read_b128 a[68:71], v8 offset:10240
    v_mfma_f32_16x16x32_bf16 v[92:95], a[12:15], a[84:87], v[92:95]
    v_mfma_f32_16x16x32_bf16 v[84:87], a[4:7], a[84:87], v[84:87]
    buffer_store_dwordx2 v[248:249], v247, s[28:31], s54 offen offset:2048 sc1
    v_mfma_f32_16x16x32_bf16 v[80:83], a[0:3], a[84:87], v[80:83]
    s_add_u32 m0, s53, 61440
    s_waitcnt lgkmcnt(10)
    v_mfma_f32_16x16x32_bf16 v[96:99], a[0:3], a[88:91], v[96:99]
    s_mul_i32 s47, s65, 229376
    ds_read_b128 a[72:75], v8 offset:12288
    v_mfma_f32_16x16x32_bf16 v[100:103], a[4:7], a[88:91], v[100:103]
    v_mfma_f32_16x16x32_bf16 v[108:111], a[12:15], a[88:91], v[108:111]
    v_mfma_f32_16x16x32_bf16 v[104:107], a[8:11], a[88:91], v[104:107]
    buffer_load_dwordx4 v6, s[8:11], s47 offen offset:0 lds
    v_mfma_f32_16x16x32_bf16 v[120:123], a[8:11], a[92:95], v[120:123]
    ds_read_b128 a[76:79], v8 offset:14336
    v_mfma_f32_16x16x32_bf16 v[124:127], a[12:15], a[92:95], v[124:127]
    v_mfma_f32_16x16x32_bf16 v[116:119], a[4:7], a[92:95], v[116:119]
    v_mfma_f32_16x16x32_bf16 v[112:115], a[0:3], a[92:95], v[112:115]
    s_waitcnt lgkmcnt(2)
    v_mfma_f32_16x16x32_bf16 v[128:131], a[0:3], a[64:67], v[128:131]
    buffer_load_dwordx4 v6, s[12:15], s47 offen offset:1024 lds
    v_mfma_f32_16x16x32_bf16 v[132:135], a[4:7], a[64:67], v[132:135]
    ds_read_b128 a[80:83], v8 offset:16384
    v_mfma_f32_16x16x32_bf16 v[140:143], a[12:15], a[64:67], v[140:143]
    v_mfma_f32_16x16x32_bf16 v[136:139], a[8:11], a[64:67], v[136:139]
    v_mfma_f32_16x16x32_bf16 v[152:155], a[8:11], a[68:71], v[152:155]
    buffer_load_dwordx4 v7, s[8:11], s47 offen offset:2048 lds
    v_mfma_f32_16x16x32_bf16 v[156:159], a[12:15], a[68:71], v[156:159]
    ds_read_b128 a[84:87], v8 offset:18432
    v_mfma_f32_16x16x32_bf16 v[148:151], a[4:7], a[68:71], v[148:151]
    v_mfma_f32_16x16x32_bf16 v[144:147], a[0:3], a[68:71], v[144:147]
    s_barrier
    s_waitcnt lgkmcnt(2)
    v_mfma_f32_16x16x32_bf16 v[160:163], a[0:3], a[72:75], v[160:163]
    ds_read_b128 a[88:91], v9 offset:0
    ds_read_b64_tr_b16 a[16:17], v10 offset:32768
    v_mfma_f32_16x16x32_bf16 v[164:167], a[4:7], a[72:75], v[164:167]
    buffer_load_dwordx4 v7, s[12:15], s47 offen offset:3072 lds
    v_mfma_f32_16x16x32_bf16 v[172:175], a[12:15], a[72:75], v[172:175]
    s_add_u32 m0, s52, 40960
    ds_read_b64_tr_b16 a[18:19], v10 offset:34816
    v_mfma_f32_16x16x32_bf16 v[168:171], a[8:11], a[72:75], v[168:171]
    s_lshl_b32 s46, s65, 7
    ds_read_b64_tr_b16 a[20:21], v11 offset:32768
    v_mfma_f32_16x16x32_bf16 v[184:187], a[8:11], a[76:79], v[184:187]
    ds_read_b128 a[92:95], v9 offset:2048
    ds_read_b64_tr_b16 a[22:23], v11 offset:34816
    v_mfma_f32_16x16x32_bf16 v[188:191], a[12:15], a[76:79], v[188:191]
    ds_read_b64_tr_b16 a[24:25], v10 offset:33792
    ds_read_b64_tr_b16 a[26:27], v10 offset:35840
    v_mfma_f32_16x16x32_bf16 v[180:183], a[4:7], a[76:79], v[180:183]
    buffer_load_dwordx4 v1, s[4:7], s46 offen offset:0 lds
    v_mfma_f32_16x16x32_bf16 v[176:179], a[0:3], a[76:79], v[176:179]
    ds_read_b64_tr_b16 a[28:29], v11 offset:33792
    s_waitcnt lgkmcnt(9)
    v_mfma_f32_16x16x32_bf16 v[192:195], a[0:3], a[80:83], v[192:195]
    ds_read_b128 a[64:67], v9 offset:4096
    ds_read_b64_tr_b16 a[30:31], v11 offset:35840
    v_mfma_f32_16x16x32_bf16 v[196:199], a[4:7], a[80:83], v[196:199]
    v_mfma_f32_16x16x32_bf16 v[204:207], a[12:15], a[80:83], v[204:207]
    v_mfma_f32_16x16x32_bf16 v[200:203], a[8:11], a[80:83], v[200:203]
    buffer_load_dwordx4 v2, s[4:7], s46 offen offset:1024 lds
    v_mfma_f32_16x16x32_bf16 v[216:219], a[8:11], a[84:87], v[216:219]
    ds_read_b128 a[68:71], v9 offset:6144
    v_mfma_f32_16x16x32_bf16 v[220:223], a[12:15], a[84:87], v[220:223]
    v_mfma_f32_16x16x32_bf16 v[212:215], a[4:7], a[84:87], v[212:215]
    v_mfma_f32_16x16x32_bf16 v[208:211], a[0:3], a[84:87], v[208:211]
    s_waitcnt lgkmcnt(1)
    v_mfma_f32_16x16x32_bf16 v[64:67], a[16:19], a[88:91], v[64:67]
    buffer_load_dwordx4 v3, s[4:7], s46 offen offset:2048 lds
    v_mfma_f32_16x16x32_bf16 v[68:71], a[20:23], a[88:91], v[68:71]
    ds_read_b128 a[72:75], v9 offset:8192
    v_mfma_f32_16x16x32_bf16 v[76:79], a[28:31], a[88:91], v[76:79]
    v_mfma_f32_16x16x32_bf16 v[72:75], a[24:27], a[88:91], v[72:75]
    v_mfma_f32_16x16x32_bf16 v[88:91], a[24:27], a[92:95], v[88:91]
    buffer_load_dwordx4 v4, s[4:7], s46 offen offset:3072 lds
    v_mfma_f32_16x16x32_bf16 v[92:95], a[28:31], a[92:95], v[92:95]
    s_add_u32 m0, s52, 45056
    ds_read_b128 a[76:79], v9 offset:10240
    v_mfma_f32_16x16x32_bf16 v[84:87], a[20:23], a[92:95], v[84:87]
    s_nop 0
    v_mfma_f32_16x16x32_bf16 v[80:83], a[16:19], a[92:95], v[80:83]
    s_waitcnt lgkmcnt(2)
    v_mfma_f32_16x16x32_bf16 v[96:99], a[16:19], a[64:67], v[96:99]
    ds_read_b128 a[80:83], v9 offset:12288
    v_mfma_f32_16x16x32_bf16 v[100:103], a[20:23], a[64:67], v[100:103]
    buffer_load_dwordx4 v5, s[4:7], s46 offen offset:0 lds
    v_mfma_f32_16x16x32_bf16 v[108:111], a[28:31], a[64:67], v[108:111]
    s_add_u32 m0, s53, 77824
    v_mfma_f32_16x16x32_bf16 v[104:107], a[24:27], a[64:67], v[104:107]
    s_add_u32 s47, s47, 114688
    v_mfma_f32_16x16x32_bf16 v[120:123], a[24:27], a[68:71], v[120:123]
    ds_read_b128 a[84:87], v9 offset:14336
    v_mfma_f32_16x16x32_bf16 v[124:127], a[28:31], a[68:71], v[124:127]
    buffer_load_dwordx4 v6, s[8:11], s47 offen offset:0 lds
    v_mfma_f32_16x16x32_bf16 v[116:119], a[20:23], a[68:71], v[116:119]
    v_mfma_f32_16x16x32_bf16 v[112:115], a[16:19], a[68:71], v[112:115]
    s_waitcnt lgkmcnt(2)
    v_mfma_f32_16x16x32_bf16 v[128:131], a[16:19], a[72:75], v[128:131]
    ds_read_b128 a[88:91], v9 offset:16384
L_pad_ffn_1:
    s_cbranch_execz L_ret_ffn
    v_mfma_f32_16x16x32_bf16 v[132:135], a[20:23], a[72:75], v[132:135]
    v_mfma_f32_16x16x32_bf16 v[140:143], a[28:31], a[72:75], v[140:143]
    buffer_load_dwordx4 v6, s[12:15], s47 offen offset:1024 lds
    v_mfma_f32_16x16x32_bf16 v[136:139], a[24:27], a[72:75], v[136:139]
    v_mfma_f32_16x16x32_bf16 v[152:155], a[24:27], a[76:79], v[152:155]
    ds_read_b128 a[92:95], v9 offset:18432
    v_mfma_f32_16x16x32_bf16 v[156:159], a[28:31], a[76:79], v[156:159]
    v_mfma_f32_16x16x32_bf16 v[148:151], a[20:23], a[76:79], v[148:151]
    v_mfma_f32_16x16x32_bf16 v[144:147], a[16:19], a[76:79], v[144:147]
    s_waitcnt vmcnt(18)
    s_barrier
    s_waitcnt lgkmcnt(2)
    v_mfma_f32_16x16x32_bf16 v[160:163], a[16:19], a[80:83], v[160:163]
    buffer_load_dwordx4 v7, s[8:11], s47 offen offset:2048 lds
    v_mfma_f32_16x16x32_bf16 v[164:167], a[20:23], a[80:83], v[164:167]
    ds_read_b128 a[64:67], v8 offset:20480
    ds_read_b64_tr_b16 a[0:1], v10 offset:49152
    v_mfma_f32_16x16x32_bf16 v[172:175], a[28:31], a[80:83], v[172:175]
    ds_read_b64_tr_b16 a[2:3], v10 offset:51200
    ds_read_b64_tr_b16 a[4:5], v11 offset:49152
    v_mfma_f32_16x16x32_bf16 v[168:171], a[24:27], a[80:83], v[168:171]
    buffer_load_dwordx4 v7, s[12:15], s47 offen offset:3072 lds
    v_mfma_f32_16x16x32_bf16 v[184:187], a[24:27], a[84:87], v[184:187]
    ds_read_b128 a[68:71], v8 offset:22528
    ds_read_b64_tr_b16 a[6:7], v11 offset:51200
    v_mfma_f32_16x16x32_bf16 v[188:191], a[28:31], a[84:87], v[188:191]
    ds_read_b64_tr_b16 a[8:9], v10 offset:50176
    ds_read_b64_tr_b16 a[10:11], v10 offset:52224
    v_mfma_f32_16x16x32_bf16 v[180:183], a[20:23], a[84:87], v[180:183]
    ds_read_b64_tr_b16 a[12:13], v11 offset:50176
    ds_read_b64_tr_b16 a[14:15], v11 offset:52224
    v_mfma_f32_16x16x32_bf16 v[176:179], a[16:19], a[84:87], v[176:179]
    s_waitcnt lgkmcnt(10)
    v_mfma_f32_16x16x32_bf16 v[192:195], a[16:19], a[88:91], v[192:195]
    global_load_dword v48, v55, s[36:37]
    v_mfma_f32_16x16x32_bf16 v[196:199], a[20:23], a[88:91], v[196:199]
    s_add_u32 m0, s52, 143360
    ds_read_b128 a[72:75], v8 offset:24576
    v_mfma_f32_16x16x32_bf16 v[204:207], a[28:31], a[88:91], v[204:207]
    s_lshl_b32 s46, s66, 7
    v_mfma_f32_16x16x32_bf16 v[200:203], a[24:27], a[88:91], v[200:203]
    v_mfma_f32_16x16x32_bf16 v[216:219], a[24:27], a[92:95], v[216:219]
    ds_read_b128 a[76:79], v8 offset:26624
    v_mfma_f32_16x16x32_bf16 v[220:223], a[28:31], a[92:95], v[220:223]
    buffer_load_dwordx4 v1, s[4:7], s46 offen offset:0 lds
    v_mfma_f32_16x16x32_bf16 v[212:215], a[20:23], a[92:95], v[212:215]
    v_mfma_f32_16x16x32_bf16 v[208:211], a[16:19], a[92:95], v[208:211]
    s_waitcnt lgkmcnt(2)
    v_mfma_f32_16x16x32_bf16 v[64:67], a[0:3], a[64:67], v[64:67]
    ds_read_b128 a[80:83], v8 offset:28672
    v_mfma_f32_16x16x32_bf16 v[68:71], a[4:7], a[64:67], v[68:71]
    v_mfma_f32_16x16x32_bf16 v[76:79], a[12:15], a[64:67], v[76:79]
    buffer_load_dwordx4 v2, s[4:7], s46 offen offset:1024 lds
    v_mfma_f32_16x16x32_bf16 v[72:75], a[8:11], a[64:67], v[72:75]
    v_mfma_f32_16x16x32_bf16 v[88:91], a[8:11], a[68:71], v[88:91]
    ds_read_b128 a[84:87], v8 offset:30720
    v_mfma_f32_16x16x32_bf16 v[92:95], a[12:15], a[68:71], v[92:95]
    v_mfma_f32_16x16x32_bf16 v[84:87], a[4:7], a[68:71], v[84:87]
    buffer_load_dwordx4 v3, s[4:7], s46 offen offset:2048 lds
    v_mfma_f32_16x16x32_bf16 v[80:83], a[0:3], a[68:71], v[80:83]
    s_waitcnt lgkmcnt(2)
    v_mfma_f32_16x16x32_bf16 v[96:99], a[0:3], a[72:75], v[96:99]
    ds_read_b128 a[88:91], v8 offset:32768
    v_mfma_f32_16x16x32_bf16 v[100:103], a[4:7], a[72:75], v[100:103]
    v_mfma_f32_16x16x32_bf16 v[108:111], a[12:15], a[72:75], v[108:111]
    v_mfma_f32_16x16x32_bf16 v[104:107], a[8:11], a[72:75], v[104:107]
    buffer_load_dwordx4 v4, s[4:7], s46 offen offset:3072 lds
    v_mfma_f32_16x16x32_bf16 v[120:123], a[8:11], a[76:79], v[120:123]
    s_add_u32 m0, s52, 147456
    ds_read_b128 a[92:95], v8 offset:34816
    v_mfma_f32_16x16x32_bf16 v[124:127], a[12:15], a[76:79], v[124:127]
    s_nop 0
    v_mfma_f32_16x16x32_bf16 v[116:119], a[4:7], a[76:79], v[116:119]
    v_mfma_f32_16x16x32_bf16 v[112:115], a[0:3], a[76:79], v[112:115]
    s_waitcnt lgkmcnt(2)
    v_mfma_f32_16x16x32_bf16 v[128:131], a[0:3], a[80:83], v[128:131]
    buffer_load_dwordx4 v5, s[4:7], s46 offen offset:0 lds
    v_mfma_f32_16x16x32_bf16 v[132:135], a[4:7], a[80:83], v[132:135]
    s_add_u32 m0, s53, 94208
    ds_read_b128 a[64:67], v8 offset:36864
    v_mfma_f32_16x16x32_bf16 v[140:143], a[12:15], a[80:83], v[140:143]
    s_mul_i32 s47, s66, 229376
    v_mfma_f32_16x16x32_bf16 v[136:139], a[8:11], a[80:83], v[136:139]
    v_mfma_f32_16x16x32_bf16 v[152:155], a[8:11], a[84:87], v[152:155]
    buffer_load_dwordx4 v6, s[8:11], s47 offen offset:0 lds
    v_mfma_f32_16x16x32_bf16 v[156:159], a[12:15], a[84:87], v[156:159]
    ds_read_b128 a[68:71], v8 offset:38912
    v_mfma_f32_16x16x32_bf16 v[148:151], a[4:7], a[84:87], v[148:151]
    v_mfma_f32_16x16x32_bf16 v[144:147], a[0:3], a[84:87], v[144:147]
    s_waitcnt vmcnt(23)
    s_barrier
    s_waitcnt lgkmcnt(2)
    v_mfma_f32_16x16x32_bf16 v[160:163], a[0:3], a[88:91], v[160:163]
    ds_read_b128 a[72:75], v9 offset:20480
    ds_read_b64_tr_b16 a[16:17], v12 offset:0
    v_mfma_f32_16x16x32_bf16 v[164:167], a[4:7], a[88:91], v[164:167]
    buffer_load_dwordx4 v6, s[12:15], s47 offen offset:1024 lds
    v_mfma_f32_16x16x32_bf16 v[172:175], a[12:15], a[88:91], v[172:175]
    ds_read_b64_tr_b16 a[18:19], v12 offset:2048
    ds_read_b64_tr_b16 a[20:21], v13 offset:0
    v_mfma_f32_16x16x32_bf16 v[168:171], a[8:11], a[88:91], v[168:171]
    ds_read_b64_tr_b16 a[22:23], v13 offset:2048
    ds_read_b64_tr_b16 a[24:25], v12 offset:1024
    v_mfma_f32_16x16x32_bf16 v[184:187], a[8:11], a[92:95], v[184:187]
    ds_read_b128 a[76:79], v9 offset:22528
    ds_read_b64_tr_b16 a[26:27], v12 offset:3072
    v_mfma_f32_16x16x32_bf16 v[188:191], a[12:15], a[92:95], v[188:191]
    ds_read_b64_tr_b16 a[28:29], v13 offset:1024
    ds_read_b64_tr_b16 a[30:31], v13 offset:3072
    v_mfma_f32_16x16x32_bf16 v[180:183], a[4:7], a[92:95], v[180:183]
    buffer_load_dwordx4 v7, s[8:11], s47 offen offset:2048 lds
    v_mfma_f32_16x16x32_bf16 v[176:179], a[0:3], a[92:95], v[176:179]
    s_waitcnt lgkmcnt(10)
    v_mfma_f32_16x16x32_bf16 v[192:195], a[0:3], a[64:67], v[192:195]
    ds_read_b128 a[80:83], v9 offset:24576
    v_mfma_f32_16x16x32_bf16 v[196:199], a[4:7], a[64:67], v[196:199]
    v_mfma_f32_16x16x32_bf16 v[204:207], a[12:15], a[64:67], v[204:207]
    v_mfma_f32_16x16x32_bf16 v[200:203], a[8:11], a[64:67], v[200:203]
    buffer_load_dwordx4 v7, s[12:15], s47 offen offset:3072 lds
    v_mfma_f32_16x16x32_bf16 v[216:219], a[8:11], a[68:71], v[216:219]
    s_add_u32 m0, s53, 110592
    ds_read_b128 a[84:87], v9 offset:26624
    v_mfma_f32_16x16x32_bf16 v[220:223], a[12:15], a[68:71], v[220:223]
    s_add_u32 s47, s47, 114688
    v_mfma_f32_16x16x32_bf16 v[212:215], a[4:7], a[68:71], v[212:215]
    v_mfma_f32_16x16x32_bf16 v[208:211], a[0:3], a[68:71], v[208:211]
    s_waitcnt lgkmcnt(2)
    v_mfma_f32_16x16x32_bf16 v[64:67], a[16:19], a[72:75], v[64:67]
    buffer_load_dwordx4 v6, s[8:11], s47 offen offset:0 lds
    v_mfma_f32_16x16x32_bf16 v[68:71], a[20:23], a[72:75], v[68:71]
    ds_read_b128 a[88:91], v9 offset:28672
    v_mfma_f32_16x16x32_bf16 v[76:79], a[28:31], a[72:75], v[76:79]
    v_mfma_f32_16x16x32_bf16 v[72:75], a[24:27], a[72:75], v[72:75]
    v_mfma_f32_16x16x32_bf16 v[88:91], a[24:27], a[76:79], v[88:91]
    buffer_load_dwordx4 v6, s[12:15], s47 offen offset:1024 lds
    v_mfma_f32_16x16x32_bf16 v[92:95], a[28:31], a[76:79], v[92:95]
    ds_read_b128 a[92:95], v9 offset:30720
    v_mfma_f32_16x16x32_bf16 v[84:87], a[20:23], a[76:79], v[84:87]
    v_mfma_f32_16x16x32_bf16 v[80:83], a[16:19], a[76:79], v[80:83]
    s_waitcnt lgkmcnt(2)
    v_mfma_f32_16x16x32_bf16 v[96:99], a[16:19], a[80:83], v[96:99]
    ds_read_b128 a[64:67], v9 offset:32768
    v_mfma_f32_16x16x32_bf16 v[100:103], a[20:23], a[80:83], v[100:103]
    buffer_load_dwordx4 v7, s[8:11], s47 offen offset:2048 lds
    v_mfma_f32_16x16x32_bf16 v[108:111], a[28:31], a[80:83], v[108:111]
    v_mfma_f32_16x16x32_bf16 v[104:107], a[24:27], a[80:83], v[104:107]
    v_mfma_f32_16x16x32_bf16 v[120:123], a[24:27], a[84:87], v[120:123]
    ds_read_b128 a[68:71], v9 offset:34816
    v_mfma_f32_16x16x32_bf16 v[124:127], a[28:31], a[84:87], v[124:127]
    buffer_load_dwordx4 v7, s[12:15], s47 offen offset:3072 lds
    v_mfma_f32_16x16x32_bf16 v[116:119], a[20:23], a[84:87], v[116:119]
    s_add_u32 m0, s53, 0
    v_mfma_f32_16x16x32_bf16 v[112:115], a[16:19], a[84:87], v[112:115]
    s_mul_i32 s45, s3, 28
    s_waitcnt lgkmcnt(2)
    v_mfma_f32_16x16x32_bf16 v[128:131], a[16:19], a[88:91], v[128:131]
    ds_read_b128 a[72:75], v9 offset:36864
    v_mfma_f32_16x16x32_bf16 v[132:135], a[20:23], a[88:91], v[132:135]
    v_mfma_f32_16x16x32_bf16 v[140:143], a[28:31], a[88:91], v[140:143]
    buffer_load_dwordx4 v14, s[20:23], s45 offen offset:0 lds
    v_mfma_f32_16x16x32_bf16 v[136:139], a[24:27], a[88:91], v[136:139]
    v_mfma_f32_16x16x32_bf16 v[152:155], a[24:27], a[92:95], v[152:155]
    ds_read_b128 a[76:79], v9 offset:38912
    v_mfma_f32_16x16x32_bf16 v[156:159], a[28:31], a[92:95], v[156:159]
    v_mfma_f32_16x16x32_bf16 v[148:151], a[20:23], a[92:95], v[148:151]
    v_mfma_f32_16x16x32_bf16 v[144:147], a[16:19], a[92:95], v[144:147]
    s_waitcnt vmcnt(5)
    s_barrier
    s_waitcnt lgkmcnt(2)
    v_mfma_f32_16x16x32_bf16 v[160:163], a[16:19], a[64:67], v[160:163]
    buffer_load_dwordx4 v15, s[20:23], s45 offen offset:1024 lds
    v_mfma_f32_16x16x32_bf16 v[164:167], a[20:23], a[64:67], v[164:167]
    ds_read_b128 a[80:83], v8 offset:40960
    ds_read_b64_tr_b16 a[0:1], v10 offset:0
    v_mfma_f32_16x16x32_bf16 v[172:175], a[28:31], a[64:67], v[172:175]
    ds_read_b64_tr_b16 a[2:3], v10 offset:2048
    ds_read_b64_tr_b16 a[4:5], v11 offset:0
    v_mfma_f32_16x16x32_bf16 v[168:171], a[24:27], a[64:67], v[168:171]
    buffer_load_dwordx4 v16, s[20:23], s45 offen offset:2048 lds
    v_mfma_f32_16x16x32_bf16 v[184:187], a[24:27], a[68:71], v[184:187]
    ds_read_b128 a[84:87], v9 offset:40960
    ds_read_b64_tr_b16 a[6:7], v11 offset:2048
    v_mfma_f32_16x16x32_bf16 v[188:191], a[28:31], a[68:71], v[188:191]
    ds_read_b64_tr_b16 a[8:9], v10 offset:1024
    ds_read_b64_tr_b16 a[10:11], v10 offset:3072
    v_mfma_f32_16x16x32_bf16 v[180:183], a[20:23], a[68:71], v[180:183]
    ds_read_b64_tr_b16 a[12:13], v11 offset:1024
    ds_read_b64_tr_b16 a[14:15], v11 offset:3072
    v_mfma_f32_16x16x32_bf16 v[176:179], a[16:19], a[68:71], v[176:179]
    ds_read_b64_tr_b16 a[32:33], v10 offset:16384
    s_waitcnt lgkmcnt(11)
    v_mfma_f32_16x16x32_bf16 v[192:195], a[16:19], a[72:75], v[192:195]
    buffer_load_dwordx4 v17, s[20:23], s45 offen offset:3072 lds
    v_mfma_f32_16x16x32_bf16 v[196:199], a[20:23], a[72:75], v[196:199]
    s_add_u32 m0, s53, 126976
    ds_read_b128 a[88:91], v20 offset:0
    v_mfma_f32_16x16x32_bf16 v[204:207], a[28:31], a[72:75], v[204:207]
    s_mul_i32 s45, s69, 28
    ds_read_b64_tr_b16 a[34:35], v10 offset:18432
    v_mfma_f32_16x16x32_bf16 v[200:203], a[24:27], a[72:75], v[200:203]
    ds_read_b64_tr_b16 a[36:37], v11 offset:16384
    ds_read_b64_tr_b16 a[38:39], v11 offset:18432
    v_mfma_f32_16x16x32_bf16 v[216:219], a[24:27], a[76:79], v[216:219]
    ds_read_b128 a[92:95], v21 offset:0
    ds_read_b64_tr_b16 a[40:41], v10 offset:17408
    v_mfma_f32_16x16x32_bf16 v[220:223], a[28:31], a[76:79], v[220:223]
    buffer_load_dwordx4 v14, s[20:23], s45 offen offset:0 lds
    v_mfma_f32_16x16x32_bf16 v[212:215], a[20:23], a[76:79], v[212:215]
    ds_read_b64_tr_b16 a[42:43], v10 offset:19456
    ds_read_b64_tr_b16 a[44:45], v11 offset:17408
    v_mfma_f32_16x16x32_bf16 v[208:211], a[16:19], a[76:79], v[208:211]
    ds_read_b64_tr_b16 a[46:47], v11 offset:19456
    ds_read_b64_tr_b16 a[48:49], v10 offset:32768
    ds_read_b64_tr_b16 a[50:51], v10 offset:34816
    ds_read_b64_tr_b16 a[52:53], v11 offset:32768
    ds_read_b64_tr_b16 a[54:55], v11 offset:34816
    ds_read_b64_tr_b16 a[56:57], v10 offset:33792
    ds_read_b64_tr_b16 a[58:59], v10 offset:35840
    ds_read_b64_tr_b16 a[60:61], v11 offset:33792
    ds_read_b64_tr_b16 a[62:63], v11 offset:35840
    s_waitcnt vmcnt(5) lgkmcnt(0)
    s_barrier
    v_mfma_f32_16x16x32_bf16 v[64:67], a[0:3], a[80:83], v[64:67]
    ds_read_b128 a[64:67], v8 offset:43008
    ds_read_b64_tr_b16 a[16:17], v10 offset:49152
    v_mfma_f32_16x16x32_bf16 v[68:71], a[4:7], a[80:83], v[68:71]
    ds_read_b64_tr_b16 a[18:19], v10 offset:51200
    ds_read_b64_tr_b16 a[20:21], v11 offset:49152
    v_mfma_f32_16x16x32_bf16 v[76:79], a[12:15], a[80:83], v[76:79]
    buffer_load_dwordx4 v15, s[20:23], s45 offen offset:1024 lds
    v_mfma_f32_16x16x32_bf16 v[72:75], a[8:11], a[80:83], v[72:75]
    ds_read_b64_tr_b16 a[22:23], v11 offset:51200
    v_mfma_f32_16x16x32_bf16 v[72:75], a[40:43], a[84:87], v[72:75]
    ds_read_b128 a[68:71], v9 offset:43008
    ds_read_b64_tr_b16 a[24:25], v10 offset:50176
    v_mfma_f32_16x16x32_bf16 v[76:79], a[44:47], a[84:87], v[76:79]
    ds_read_b64_tr_b16 a[26:27], v10 offset:52224
    ds_read_b64_tr_b16 a[28:29], v11 offset:50176
    v_mfma_f32_16x16x32_bf16 v[68:71], a[36:39], a[84:87], v[68:71]
    buffer_load_dwordx4 v16, s[20:23], s45 offen offset:2048 lds
    v_mfma_f32_16x16x32_bf16 v[64:67], a[32:35], a[84:87], v[64:67]
    ds_read_b64_tr_b16 a[30:31], v11 offset:52224
    v_mfma_f32_16x16x32_bf16 v[64:67], a[48:51], a[88:91], v[64:67]
    ds_read_b128 a[72:75], v20 offset:2048
    v_mfma_f32_16x16x32_bf16 v[68:71], a[52:55], a[88:91], v[68:71]
    v_mfma_f32_16x16x32_bf16 v[76:79], a[60:63], a[88:91], v[76:79]
    v_mfma_f32_16x16x32_bf16 v[72:75], a[56:59], a[88:91], v[72:75]
    s_waitcnt lgkmcnt(1)
    v_mfma_f32_16x16x32_bf16 v[72:75], a[24:27], a[92:95], v[72:75]
    buffer_load_dwordx4 v17, s[20:23], s45 offen offset:3072 lds
    v_mfma_f32_16x16x32_bf16 v[76:79], a[28:31], a[92:95], v[76:79]
    s_add_u32 m0, s53, 61440
    ds_read_b128 a[76:79], v21 offset:2048
    v_mfma_f32_16x16x32_bf16 v[68:71], a[20:23], a[92:95], v[68:71]
    s_mul_i32 s45, s70, 28
    v_mfma_f32_16x16x32_bf16 v[64:67], a[16:19], a[92:95], v[64:67]
    v_mfma_f32_16x16x32_bf16 v[80:83], a[0:3], a[64:67], v[80:83]
    buffer_load_dwordx4 v14, s[20:23], s45 offen offset:0 lds
    v_mfma_f32_16x16x32_bf16 v[84:87], a[4:7], a[64:67], v[84:87]
    ds_read_b128 a[80:83], v8 offset:45056
    v_mfma_f32_16x16x32_bf16 v[92:95], a[12:15], a[64:67], v[92:95]
    v_mfma_f32_16x16x32_bf16 v[88:91], a[8:11], a[64:67], v[88:91]
    v_max_f32 v64, 0, v64
    v_max_f32 v65, 0, v65
    v_mfma_f32_16x16x32_bf16 v[88:91], a[40:43], a[68:71], v[88:91]
    buffer_load_dwordx4 v15, s[20:23], s45 offen offset:1024 lds
    v_mfma_f32_16x16x32_bf16 v[92:95], a[44:47], a[68:71], v[92:95]
    ds_read_b128 a[84:87], v9 offset:45056
    v_max_f32 v66, 0, v66
    v_mfma_f32_16x16x32_bf16 v[84:87], a[36:39], a[68:71], v[84:87]
    v_max_f32 v67, 0, v67
    v_max_f32 v68, 0, v68
    v_mfma_f32_16x16x32_bf16 v[80:83], a[32:35], a[68:71], v[80:83]
    v_max_f32 v69, 0, v69
    s_waitcnt lgkmcnt(2)
    v_mfma_f32_16x16x32_bf16 v[80:83], a[48:51], a[72:75], v[80:83]
    ds_read_b128 a[88:91], v20 offset:4096
    v_max_f32 v70, 0, v70
    v_mfma_f32_16x16x32_bf16 v[84:87], a[52:55], a[72:75], v[84:87]
    buffer_load_dwordx4 v16, s[20:23], s45 offen offset:2048 lds
    v_mfma_f32_16x16x32_bf16 v[92:95], a[60:63], a[72:75], v[92:95]
    v_max_f32 v71, 0, v71
    v_mul_f32 v64, v64, v72
    v_mfma_f32_16x16x32_bf16 v[88:91], a[56:59], a[72:75], v[88:91]
    v_mul_f32 v65, v65, v73
    v_mul_f32 v66, v66, v74
    v_mfma_f32_16x16x32_bf16 v[88:91], a[24:27], a[76:79], v[88:91]
    ds_read_b128 a[92:95], v21 offset:4096
    v_mul_f32 v67, v67, v75
    v_mfma_f32_16x16x32_bf16 v[92:95], a[28:31], a[76:79], v[92:95]
    v_mul_f32 v68, v68, v76
    v_mul_f32 v69, v69, v77
    v_mfma_f32_16x16x32_bf16 v[84:87], a[20:23], a[76:79], v[84:87]
    buffer_load_dwordx4 v17, s[20:23], s45 offen offset:3072 lds
    v_mfma_f32_16x16x32_bf16 v[80:83], a[16:19], a[76:79], v[80:83]
    s_add_u32 m0, s53, 77824
    s_waitcnt lgkmcnt(2)
    v_mul_f32 v70, v70, v78
    v_mul_f32 v71, v71, v79
    v_cvt_pk_bf16_f32 v64, v64, v65
    v_cvt_pk_bf16_f32 v65, v66, v67
    v_cvt_pk_bf16_f32 v66, v68, v69
    v_cvt_pk_bf16_f32 v67, v70, v71
    buffer_store_dwordx4 v[64:67], v42, s[16:19], s3 offen sc1
    v_mfma_f32_16x16x32_bf16 v[96:99], a[0:3], a[80:83], v[96:99]
    s_mul_i32 s45, s71, 28
    ds_read_b128 a[64:67], v8 offset:47104
    v_mfma_f32_16x16x32_bf16 v[100:103], a[4:7], a[80:83], v[100:103]
    v_mfma_f32_16x16x32_bf16 v[108:111], a[12:15], a[80:83], v[108:111]
    v_mfma_f32_16x16x32_bf16 v[104:107], a[8:11], a[80:83], v[104:107]
    buffer_load_dwordx4 v14, s[20:23], s45 offen offset:0 lds
    v_mfma_f32_16x16x32_bf16 v[104:107], a[40:43], a[84:87], v[104:107]
    ds_read_b128 a[68:71], v9 offset:47104
    v_max_f32 v80, 0, v80
    v_mfma_f32_16x16x32_bf16 v[108:111], a[44:47], a[84:87], v[108:111]
    v_max_f32 v81, 0, v81
    v_max_f32 v82, 0, v82
    v_mfma_f32_16x16x32_bf16 v[100:103], a[36:39], a[84:87], v[100:103]
    v_max_f32 v83, 0, v83
    v_max_f32 v84, 0, v84
    v_mfma_f32_16x16x32_bf16 v[96:99], a[32:35], a[84:87], v[96:99]
    v_max_f32 v85, 0, v85
    s_waitcnt lgkmcnt(2)
    v_mfma_f32_16x16x32_bf16 v[96:99], a[48:51], a[88:91], v[96:99]
    buffer_load_dwordx4 v15, s[20:23], s45 offen offset:1024 lds
    v_mfma_f32_16x16x32_bf16 v[100:103], a[52:55], a[88:91], v[100:103]
    ds_read_b128 a[72:75], v20 offset:6144
    v_max_f32 v86, 0, v86
    v_mfma_f32_16x16x32_bf16 v[108:111], a[60:63], a[88:91], v[108:111]
    v_max_f32 v87, 0, v87
    v_mul_f32 v80, v80, v88
    v_mfma_f32_16x16x32_bf16 v[104:107], a[56:59], a[88:91], v[104:107]
    v_mul_f32 v81, v81, v89
    v_mul_f32 v82, v82, v90
    v_mfma_f32_16x16x32_bf16 v[104:107], a[24:27], a[92:95], v[104:107]
    buffer_load_dwordx4 v16, s[20:23], s45 offen offset:2048 lds
    v_mfma_f32_16x16x32_bf16 v[108:111], a[28:31], a[92:95], v[108:111]
    ds_read_b128 a[76:79], v21 offset:6144
    v_mul_f32 v83, v83, v91
    v_mfma_f32_16x16x32_bf16 v[100:103], a[20:23], a[92:95], v[100:103]
    v_mul_f32 v84, v84, v92
    v_mul_f32 v85, v85, v93
    v_mfma_f32_16x16x32_bf16 v[96:99], a[16:19], a[92:95], v[96:99]
    v_mul_f32 v86, v86, v94
    s_waitcnt lgkmcnt(2)
    v_mul_f32 v87, v87, v95
    v_cvt_pk_bf16_f32 v80, v80, v81
    v_cvt_pk_bf16_f32 v81, v82, v83
    v_cvt_pk_bf16_f32 v82, v84, v85
    v_cvt_pk_bf16_f32 v83, v86, v87
    buffer_store_dwordx4 v[80:83], v43, s[16:19], s3 offen sc1
    v_mfma_f32_16x16x32_bf16 v[112:115], a[0:3], a[64:67], v[112:115]
    ds_read_b128 a[80:83], v8 offset:49152
    v_mfma_f32_16x16x32_bf16 v[116:119], a[4:7], a[64:67], v[116:119]
    buffer_load_dwordx4 v17, s[20:23], s45 offen offset:3072 lds
    v_mfma_f32_16x16x32_bf16 v[124:127], a[12:15], a[64:67], v[124:127]
    v_mfma_f32_16x16x32_bf16 v[120:123], a[8:11], a[64:67], v[120:123]
    v_max_f32 v96, 0, v96
    v_max_f32 v97, 0, v97
    v_mfma_f32_16x16x32_bf16 v[120:123], a[40:43], a[68:71], v[120:123]
    ds_read_b128 a[84:87], v9 offset:49152
    v_max_f32 v98, 0, v98
    v_mfma_f32_16x16x32_bf16 v[124:127], a[44:47], a[68:71], v[124:127]
    v_max_f32 v99, 0, v99
    v_max_f32 v100, 0, v100
    v_mfma_f32_16x16x32_bf16 v[116:119], a[36:39], a[68:71], v[116:119]
    v_max_f32 v101, 0, v101
    v_max_f32 v102, 0, v102
    v_mfma_f32_16x16x32_bf16 v[112:115], a[32:35], a[68:71], v[112:115]
    v_max_f32 v103, 0, v103
    s_waitcnt lgkmcnt(2)
    v_mfma_f32_16x16x32_bf16 v[112:115], a[48:51], a[72:75], v[112:115]
    ds_read_b128 a[88:91], v20 offset:8192
    v_mul_f32 v96, v96, v104
    v_mfma_f32_16x16x32_bf16 v[116:119], a[52:55], a[72:75], v[116:119]
    v_mul_f32 v97, v97, v105
    v_mul_f32 v98, v98, v106
    v_mfma_f32_16x16x32_bf16 v[124:127], a[60:63], a[72:75], v[124:127]
    v_mul_f32 v99, v99, v107
    v_mul_f32 v100, v100, v108
    v_mfma_f32_16x16x32_bf16 v[120:123], a[56:59], a[72:75], v[120:123]
    v_mul_f32 v101, v101, v109
    v_mul_f32 v102, v102, v110
    v_mfma_f32_16x16x32_bf16 v[120:123], a[24:27], a[76:79], v[120:123]
    ds_read_b128 a[92:95], v21 offset:8192
    v_mul_f32 v103, v103, v111
    v_mfma_f32_16x16x32_bf16 v[124:127], a[28:31], a[76:79], v[124:127]
    v_cvt_pk_bf16_f32 v96, v96, v97
    v_cvt_pk_bf16_f32 v97, v98, v99
    v_mfma_f32_16x16x32_bf16 v[116:119], a[20:23], a[76:79], v[116:119]
    v_cvt_pk_bf16_f32 v98, v100, v101
    v_cvt_pk_bf16_f32 v99, v102, v103
    v_mfma_f32_16x16x32_bf16 v[112:115], a[16:19], a[76:79], v[112:115]
    buffer_store_dwordx4 v[96:99], v44, s[16:19], s3 offen sc1
    s_waitcnt lgkmcnt(2)
    v_mfma_f32_16x16x32_bf16 v[128:131], a[0:3], a[80:83], v[128:131]
    ds_read_b128 a[64:67], v8 offset:51200
    v_mfma_f32_16x16x32_bf16 v[132:135], a[4:7], a[80:83], v[132:135]
    v_mfma_f32_16x16x32_bf16 v[140:143], a[12:15], a[80:83], v[140:143]
    v_mfma_f32_16x16x32_bf16 v[136:139], a[8:11], a[80:83], v[136:139]
    v_max_f32 v112, 0, v112
    v_max_f32 v113, 0, v113
    v_mfma_f32_16x16x32_bf16 v[136:139], a[40:43], a[84:87], v[136:139]
    ds_read_b128 a[68:71], v9 offset:51200
    v_max_f32 v114, 0, v114
    v_mfma_f32_16x16x32_bf16 v[140:143], a[44:47], a[84:87], v[140:143]
    v_max_f32 v115, 0, v115
    v_max_f32 v116, 0, v116
    v_mfma_f32_16x16x32_bf16 v[132:135], a[36:39], a[84:87], v[132:135]
    v_max_f32 v117, 0, v117
    v_max_f32 v118, 0, v118
    v_mfma_f32_16x16x32_bf16 v[128:131], a[32:35], a[84:87], v[128:131]
    v_max_f32 v119, 0, v119
    s_waitcnt lgkmcnt(2)
    v_mfma_f32_16x16x32_bf16 v[128:131], a[48:51], a[88:91], v[128:131]
    ds_read_b128 a[72:75], v20 offset:10240
    v_mul_f32 v112, v112, v120
    v_mfma_f32_16x16x32_bf16 v[132:135], a[52:55], a[88:91], v[132:135]
    v_mul_f32 v113, v113, v121
    v_mul_f32 v114, v114, v122
    v_mfma_f32_16x16x32_bf16 v[140:143], a[60:63], a[88:91], v[140:143]
    v_mul_f32 v115, v115, v123
    v_mul_f32 v116, v116, v124
    v_mfma_f32_16x16x32_bf16 v[136:139], a[56:59], a[88:91], v[136:139]
    v_mul_f32 v117, v117, v125
    v_mul_f32 v118, v118, v126
    v_mfma_f32_16x16x32_bf16 v[136:139], a[24:27], a[92:95], v[136:139]
    ds_read_b128 a[76:79], v21 offset:10240
    v_mul_f32 v119, v119, v127
    v_mfma_f32_16x16x32_bf16 v[140:143], a[28:31], a[92:95], v[140:143]
    v_cvt_pk_bf16_f32 v112, v112, v113
    v_cvt_pk_bf16_f32 v113, v114, v115
    v_mfma_f32_16x16x32_bf16 v[132:135], a[20:23], a[92:95], v[132:135]
    v_cvt_pk_bf16_f32 v114, v116, v117
    v_cvt_pk_bf16_f32 v115, v118, v119
    v_mfma_f32_16x16x32_bf16 v[128:131], a[16:19], a[92:95], v[128:131]
    buffer_store_dwordx4 v[112:115], v45, s[16:19], s3 offen sc1
    s_waitcnt lgkmcnt(2)
    v_mfma_f32_16x16x32_bf16 v[144:147], a[0:3], a[64:67], v[144:147]
    ds_read_b128 a[80:83], v8 offset:53248
    v_mfma_f32_16x16x32_bf16 v[148:151], a[4:7], a[64:67], v[148:151]
    v_mfma_f32_16x16x32_bf16 v[156:159], a[12:15], a[64:67], v[156:159]
    v_mfma_f32_16x16x32_bf16 v[152:155], a[8:11], a[64:67], v[152:155]
    v_max_f32 v128, 0, v128
    v_max_f32 v129, 0, v129
    v_mfma_f32_16x16x32_bf16 v[152:155], a[40:43], a[68:71], v[152:155]
    ds_read_b128 a[84:87], v9 offset:53248
    v_max_f32 v130, 0, v130
    v_mfma_f32_16x16x32_bf16 v[156:159], a[44:47], a[68:71], v[156:159]
    v_max_f32 v131, 0, v131
    v_max_f32 v132, 0, v132
    v_mfma_f32_16x16x32_bf16 v[148:151], a[36:39], a[68:71], v[148:151]
    v_max_f32 v133, 0, v133
    v_max_f32 v134, 0, v134
    v_mfma_f32_16x16x32_bf16 v[144:147], a[32:35], a[68:71], v[144:147]
    v_max_f32 v135, 0, v135
    s_waitcnt lgkmcnt(2)
    v_mfma_f32_16x16x32_bf16 v[144:147], a[48:51], a[72:75], v[144:147]
    ds_read_b128 a[88:91], v20 offset:12288
    v_mul_f32 v128, v128, v136
    v_mfma_f32_16x16x32_bf16 v[148:151], a[52:55], a[72:75], v[148:151]
    v_mul_f32 v129, v129, v137
    v_mul_f32 v130, v130, v138
    v_mfma_f32_16x16x32_bf16 v[156:159], a[60:63], a[72:75], v[156:159]
    v_mul_f32 v131, v131, v139
    v_mul_f32 v132, v132, v140
    v_mfma_f32_16x16x32_bf16 v[152:155], a[56:59], a[72:75], v[152:155]
    v_mul_f32 v133, v133, v141
    v_mul_f32 v134, v134, v142
    v_mfma_f32_16x16x32_bf16 v[152:155], a[24:27], a[76:79], v[152:155]
    ds_read_b128 a[92:95], v21 offset:12288
    v_mul_f32 v135, v135, v143
    v_mfma_f32_16x16x32_bf16 v[156:159], a[28:31], a[76:79], v[156:159]
    v_cvt_pk_bf16_f32 v128, v128, v129
    v_cvt_pk_bf16_f32 v129, v130, v131
    v_mfma_f32_16x16x32_bf16 v[148:151], a[20:23], a[76:79], v[148:151]
    v_cvt_pk_bf16_f32 v130, v132, v133
    v_cvt_pk_bf16_f32 v131, v134, v135
    v_mfma_f32_16x16x32_bf16 v[144:147], a[16:19], a[76:79], v[144:147]
    buffer_store_dwordx4 v[128:131], v46, s[16:19], s3 offen sc1
    s_waitcnt lgkmcnt(2)
    v_mfma_f32_16x16x32_bf16 v[160:163], a[0:3], a[80:83], v[160:163]
    ds_read_b128 a[64:67], v8 offset:55296
    v_mfma_f32_16x16x32_bf16 v[164:167], a[4:7], a[80:83], v[164:167]
    v_mfma_f32_16x16x32_bf16 v[172:175], a[12:15], a[80:83], v[172:175]
    v_mfma_f32_16x16x32_bf16 v[168:171], a[8:11], a[80:83], v[168:171]
    v_max_f32 v144, 0, v144
    v_max_f32 v145, 0, v145
    v_mfma_f32_16x16x32_bf16 v[168:171], a[40:43], a[84:87], v[168:171]
    ds_read_b128 a[68:71], v9 offset:55296
    v_max_f32 v146, 0, v146
    v_mfma_f32_16x16x32_bf16 v[172:175], a[44:47], a[84:87], v[172:175]
    v_max_f32 v147, 0, v147
    v_max_f32 v148, 0, v148
    v_mfma_f32_16x16x32_bf16 v[164:167], a[36:39], a[84:87], v[164:167]
    v_max_f32 v149, 0, v149
    v_max_f32 v150, 0, v150
    v_mfma_f32_16x16x32_bf16 v[160:163], a[32:35], a[84:87], v[160:163]
    v_max_f32 v151, 0, v151
    s_waitcnt lgkmcnt(2)
    v_mfma_f32_16x16x32_bf16 v[160:163], a[48:51], a[88:91], v[160:163]
    ds_read_b128 a[72:75], v20 offset:14336
    v_mul_f32 v144, v144, v152
    v_mfma_f32_16x16x32_bf16 v[164:167], a[52:55], a[88:91], v[164:167]
    v_mul_f32 v145, v145, v153
    v_mul_f32 v146, v146, v154
    v_mfma_f32_16x16x32_bf16 v[172:175], a[60:63], a[88:91], v[172:175]
    v_mul_f32 v147, v147, v155
    v_mul_f32 v148, v148, v156
    v_mfma_f32_16x16x32_bf16 v[168:171], a[56:59], a[88:91], v[168:171]
    v_mul_f32 v149, v149, v157
    v_mul_f32 v150, v150, v158
    v_mfma_f32_16x16x32_bf16 v[168:171], a[24:27], a[92:95], v[168:171]
    ds_read_b128 a[76:79], v21 offset:14336
    v_mul_f32 v151, v151, v159
    v_mfma_f32_16x16x32_bf16 v[172:175], a[28:31], a[92:95], v[172:175]
    v_cvt_pk_bf16_f32 v144, v144, v145
    v_cvt_pk_bf16_f32 v145, v146, v147
    v_mfma_f32_16x16x32_bf16 v[164:167], a[20:23], a[92:95], v[164:167]
    v_cvt_pk_bf16_f32 v146, v148, v149
    v_cvt_pk_bf16_f32 v147, v150, v151
    v_mfma_f32_16x16x32_bf16 v[160:163], a[16:19], a[92:95], v[160:163]
    buffer_store_dwordx4 v[144:147], v240, s[16:19], s3 offen sc1
    s_waitcnt lgkmcnt(2)
    v_mfma_f32_16x16x32_bf16 v[176:179], a[0:3], a[64:67], v[176:179]
    ds_read_b128 a[80:83], v8 offset:57344
    v_mfma_f32_16x16x32_bf16 v[180:183], a[4:7], a[64:67], v[180:183]
    v_mfma_f32_16x16x32_bf16 v[188:191], a[12:15], a[64:67], v[188:191]
    v_mfma_f32_16x16x32_bf16 v[184:187], a[8:11], a[64:67], v[184:187]
    v_max_f32 v160, 0, v160
    v_max_f32 v161, 0, v161
    v_mfma_f32_16x16x32_bf16 v[184:187], a[40:43], a[68:71], v[184:187]
    ds_read_b128 a[84:87], v9 offset:57344
    v_max_f32 v162, 0, v162
    v_mfma_f32_16x16x32_bf16 v[188:191], a[44:47], a[68:71], v[188:191]
    v_max_f32 v163, 0, v163
    v_max_f32 v164, 0, v164
    v_mfma_f32_16x16x32_bf16 v[180:183], a[36:39], a[68:71], v[180:183]
    v_max_f32 v165, 0, v165
    v_max_f32 v166, 0, v166
    v_mfma_f32_16x16x32_bf16 v[176:179], a[32:35], a[68:71], v[176:179]
    v_max_f32 v167, 0, v167
    s_waitcnt lgkmcnt(2)
    v_mfma_f32_16x16x32_bf16 v[176:179], a[48:51], a[72:75], v[176:179]
    ds_read_b128 a[88:91], v20 offset:16384
    v_mul_f32 v160, v160, v168
    v_mfma_f32_16x16x32_bf16 v[180:183], a[52:55], a[72:75], v[180:183]
    v_mul_f32 v161, v161, v169
    v_mul_f32 v162, v162, v170
    v_mfma_f32_16x16x32_bf16 v[188:191], a[60:63], a[72:75], v[188:191]
    v_mul_f32 v163, v163, v171
    v_mul_f32 v164, v164, v172
    v_mfma_f32_16x16x32_bf16 v[184:187], a[56:59], a[72:75], v[184:187]
    v_mul_f32 v165, v165, v173
    v_mul_f32 v166, v166, v174
    v_mfma_f32_16x16x32_bf16 v[184:187], a[24:27], a[76:79], v[184:187]
    ds_read_b128 a[92:95], v21 offset:16384
    v_mul_f32 v167, v167, v175
    v_mfma_f32_16x16x32_bf16 v[188:191], a[28:31], a[76:79], v[188:191]
    v_cvt_pk_bf16_f32 v160, v160, v161
    v_cvt_pk_bf16_f32 v161, v162, v163
    v_mfma_f32_16x16x32_bf16 v[180:183], a[20:23], a[76:79], v[180:183]
    v_cvt_pk_bf16_f32 v162, v164, v165
    v_cvt_pk_bf16_f32 v163, v166, v167
    v_mfma_f32_16x16x32_bf16 v[176:179], a[16:19], a[76:79], v[176:179]
    buffer_store_dwordx4 v[160:163], v241, s[16:19], s3 offen sc1
    s_waitcnt lgkmcnt(2)
    v_mfma_f32_16x16x32_bf16 v[192:195], a[0:3], a[80:83], v[192:195]
    ds_read_b128 a[64:67], v8 offset:59392
    v_mfma_f32_16x16x32_bf16 v[196:199], a[4:7], a[80:83], v[196:199]
    v_mfma_f32_16x16x32_bf16 v[204:207], a[12:15], a[80:83], v[204:207]
    v_mfma_f32_16x16x32_bf16 v[200:203], a[8:11], a[80:83], v[200:203]
    v_max_f32 v176, 0, v176
    v_max_f32 v177, 0, v177
    v_mfma_f32_16x16x32_bf16 v[200:203], a[40:43], a[84:87], v[200:203]
    ds_read_b128 a[68:71], v9 offset:59392
    v_max_f32 v178, 0, v178
    v_mfma_f32_16x16x32_bf16 v[204:207], a[44:47], a[84:87], v[204:207]
    v_max_f32 v179, 0, v179
    v_max_f32 v180, 0, v180
    v_mfma_f32_16x16x32_bf16 v[196:199], a[36:39], a[84:87], v[196:199]
    v_max_f32 v181, 0, v181
    v_max_f32 v182, 0, v182
    v_mfma_f32_16x16x32_bf16 v[192:195], a[32:35], a[84:87], v[192:195]
    v_max_f32 v183, 0, v183
    s_waitcnt lgkmcnt(2)
    v_cmp_ne_u32 vcc, 1, v48
    s_cbranch_vccnz L_slow_1
L_ok_3:
    s_waitcnt vmcnt(2)
    s_mov_b64 exec, 0xffff
    buffer_store_dword v54, v49, s[28:31], s59 offen sc1
    s_mov_b64 exec, -1
    v_mfma_f32_16x16x32_bf16 v[192:195], a[48:51], a[88:91], v[192:195]
    ds_read_b128 a[72:75], v20 offset:18432
    v_mul_f32 v176, v176, v184
L_pad_ffn_2:
    s_cbranch_execz L_ret_ffn
    v_mfma_f32_16x16x32_bf16 v[196:199], a[52:55], a[88:91], v[196:199]
    v_mul_f32 v177, v177, v185
    v_mul_f32 v178, v178, v186
    v_mfma_f32_16x16x32_bf16 v[204:207], a[60:63], a[88:91], v[204:207]
    v_mul_f32 v179, v179, v187
    v_mul_f32 v180, v180, v188
    v_mfma_f32_16x16x32_bf16 v[200:203], a[56:59], a[88:91], v[200:203]
    v_mul_f32 v181, v181, v189
    v_mul_f32 v182, v182, v190
    v_mfma_f32_16x16x32_bf16 v[200:203], a[24:27], a[92:95], v[200:203]
    ds_read_b128 a[76:79], v21 offset:18432
    v_mul_f32 v183, v183, v191
    v_mfma_f32_16x16x32_bf16 v[204:207], a[28:31], a[92:95], v[204:207]
    v_cvt_pk_bf16_f32 v176, v176, v177
    v_cvt_pk_bf16_f32 v177, v178, v179
    v_mfma_f32_16x16x32_bf16 v[196:199], a[20:23], a[92:95], v[196:199]
    v_cvt_pk_bf16_f32 v178, v180, v181
    v_cvt_pk_bf16_f32 v179, v182, v183
    v_mfma_f32_16x16x32_bf16 v[192:195], a[16:19], a[92:95], v[192:195]
    buffer_store_dwordx4 v[176:179], v242, s[16:19], s3 offen sc1
    s_waitcnt lgkmcnt(2)
    v_mfma_f32_16x16x32_bf16 v[208:211], a[0:3], a[64:67], v[208:211]
    v_mfma_f32_16x16x32_bf16 v[212:215], a[4:7], a[64:67], v[212:215]
    v_mfma_f32_16x16x32_bf16 v[220:223], a[12:15], a[64:67], v[220:223]
    v_mfma_f32_16x16x32_bf16 v[216:219], a[8:11], a[64:67], v[216:219]
    v_max_f32 v192, 0, v192
    v_max_f32 v193, 0, v193
    v_mfma_f32_16x16x32_bf16 v[216:219], a[40:43], a[68:71], v[216:219]
    v_max_f32 v194, 0, v194
    v_max_f32 v195, 0, v195
    v_mfma_f32_16x16x32_bf16 v[220:223], a[44:47], a[68:71], v[220:223]
    v_max_f32 v196, 0, v196
    v_max_f32 v197, 0, v197
    v_mfma_f32_16x16x32_bf16 v[212:215], a[36:39], a[68:71], v[212:215]
    v_max_f32 v198, 0, v198
    v_max_f32 v199, 0, v199
    v_mfma_f32_16x16x32_bf16 v[208:211], a[32:35], a[68:71], v[208:211]
    v_mul_f32 v192, v192, v200
    s_waitcnt lgkmcnt(0)
    v_mfma_f32_16x16x32_bf16 v[208:211], a[48:51], a[72:75], v[208:211]
    v_mul_f32 v193, v193, v201
    v_mul_f32 v194, v194, v202
    v_mfma_f32_16x16x32_bf16 v[212:215], a[52:55], a[72:75], v[212:215]
    v_mul_f32 v195, v195, v203
    v_mul_f32 v196, v196, v204
    v_mfma_f32_16x16x32_bf16 v[220:223], a[60:63], a[72:75], v[220:223]
    v_mul_f32 v197, v197, v205
    v_mul_f32 v198, v198, v206
    v_mfma_f32_16x16x32_bf16 v[216:219], a[56:59], a[72:75], v[216:219]
    v_mul_f32 v199, v199, v207
    v_cvt_pk_bf16_f32 v192, v192, v193
    s_barrier
    v_mfma_f32_16x16x32_bf16 v[216:219], a[24:27], a[76:79], v[216:219]
    v_cvt_pk_bf16_f32 v193, v194, v195
    v_cvt_pk_bf16_f32 v194, v196, v197
    v_mfma_f32_16x16x32_bf16 v[220:223], a[28:31], a[76:79], v[220:223]
    v_cvt_pk_bf16_f32 v195, v198, v199
    v_mfma_f32_16x16x32_bf16 v[212:215], a[20:23], a[76:79], v[212:215]
    buffer_store_dwordx4 v[192:195], v243, s[16:19], s3 offen sc1
    v_mfma_f32_16x16x32_bf16 v[208:211], a[16:19], a[76:79], v[208:211]
    s_nop 7
    v_max_f32 v208, 0, v208
    v_max_f32 v209, 0, v209
    v_max_f32 v210, 0, v210
    v_max_f32 v211, 0, v211
    v_max_f32 v212, 0, v212
    v_max_f32 v213, 0, v213
    v_max_f32 v214, 0, v214
    v_max_f32 v215, 0, v215
    v_pk_mul_f32 v[208:209], v[208:209], v[216:217]
    v_pk_mul_f32 v[210:211], v[210:211], v[218:219]
    v_pk_mul_f32 v[212:213], v[212:213], v[220:221]
    v_pk_mul_f32 v[214:215], v[214:215], v[222:223]
    v_cvt_pk_bf16_f32 v208, v208, v209
    v_cvt_pk_bf16_f32 v209, v210, v211
    v_cvt_pk_bf16_f32 v210, v212, v213
    v_cvt_pk_bf16_f32 v211, v214, v215
    buffer_store_dwordx4 v[208:211], v244, s[16:19], s3 offen sc1
    ds_read_b64_tr_b16 a[160:161], v30 offset:0
    ds_read_b64_tr_b16 a[162:163], v30 offset:2048
    ds_read_b64_tr_b16 a[164:165], v31 offset:0
    ds_read_b64_tr_b16 a[166:167], v31 offset:2048
    ds_read_b64_tr_b16 a[168:169], v32 offset:0
    ds_read_b64_tr_b16 a[170:171], v32 offset:2048
    ds_read_b64_tr_b16 a[172:173], v33 offset:0
    ds_read_b64_tr_b16 a[174:175], v33 offset:2048
    s_waitcnt lgkmcnt(0)
    v_mfma_f32_16x16x32_bf16 v[224:227], a[160:163], v[64:67], 0
    s_add_u32 m0, s53, 94208
    v_mfma_f32_16x16x32_bf16 v[228:231], a[164:167], v[64:67], 0
    s_mul_i32 s45, s72, 28
    ds_read_b64_tr_b16 a[176:177], v34 offset:49152
    v_mfma_f32_16x16x32_bf16 v[232:235], a[168:171], v[64:67], 0
    ds_read_b64_tr_b16 a[178:179], v34 offset:51200
    ds_read_b64_tr_b16 a[180:181], v35 offset:49152
    v_mfma_f32_16x16x32_bf16 v[236:239], a[172:175], v[64:67], 0
    buffer_load_dwordx4 v14, s[20:23], s45 offen offset:0 lds
    v_mfma_f32_16x16x32_bf16 v[76:79], a[172:175], v[80:83], 0
    ds_read_b64_tr_b16 a[182:183], v35 offset:51200
    ds_read_b64_tr_b16 a[184:185], v36 offset:49152
    v_mfma_f32_16x16x32_bf16 v[72:75], a[168:171], v[80:83], 0
    ds_read_b64_tr_b16 a[186:187], v36 offset:51200
    ds_read_b64_tr_b16 a[188:189], v37 offset:49152
    v_mfma_f32_16x16x32_bf16 v[68:71], a[164:167], v[80:83], 0
    buffer_load_dwordx4 v15, s[20:23], s45 offen offset:1024 lds
    v_mfma_f32_16x16x32_bf16 v[64:67], a[160:163], v[80:83], 0
    ds_read_b64_tr_b16 a[190:191], v37 offset:51200
    v_mfma_f32_16x16x32_bf16 v[80:83], a[160:163], v[96:99], 0
    ds_read_b64_tr_b16 a[192:193], v30 offset:61440
    ds_read_b64_tr_b16 a[194:195], v30 offset:63488
    v_mfma_f32_16x16x32_bf16 v[84:87], a[164:167], v[96:99], 0
    buffer_load_dwordx4 v16, s[20:23], s45 offen offset:2048 lds
    v_mfma_f32_16x16x32_bf16 v[88:91], a[168:171], v[96:99], 0
    ds_read_b64_tr_b16 a[196:197], v31 offset:61440
    ds_read_b64_tr_b16 a[198:199], v31 offset:63488
    v_mfma_f32_16x16x32_bf16 v[92:95], a[172:175], v[96:99], 0
    ds_read_b64_tr_b16 a[200:201], v32 offset:61440
    ds_read_b64_tr_b16 a[202:203], v32 offset:63488
    v_mfma_f32_16x16x32_bf16 v[108:111], a[172:175], v[112:115], 0
    buffer_load_dwordx4 v17, s[20:23], s45 offen offset:3072 lds
    v_mfma_f32_16x16x32_bf16 v[104:107], a[168:171], v[112:115], 0
    s_add_u32 m0, s53, 20480
    ds_read_b64_tr_b16 a[204:205], v33 offset:61440
    v_mfma_f32_16x16x32_bf16 v[100:103], a[164:167], v[112:115], 0
    s_mul_i32 s45, s75, 49
    ds_read_b64_tr_b16 a[206:207], v33 offset:63488
    v_mfma_f32_16x16x32_bf16 v[96:99], a[160:163], v[112:115], 0
    s_lshr_b32 s45, s45, 1
    v_mfma_f32_16x16x32_bf16 v[112:115], a[160:163], v[128:131], 0
    s_add_u32 s75, s75, 57344
    ds_read_b64_tr_b16 a[208:209], v34 offset:0
    v_mfma_f32_16x16x32_bf16 v[116:119], a[164:167], v[128:131], 0
    ds_read_b64_tr_b16 a[210:211], v34 offset:2048
    ds_read_b64_tr_b16 a[212:213], v35 offset:0
    v_mfma_f32_16x16x32_bf16 v[120:123], a[168:171], v[128:131], 0
    buffer_load_dwordx4 v14, s[24:27], s45 offen offset:0 lds
    v_mfma_f32_16x16x32_bf16 v[124:127], a[172:175], v[128:131], 0
    ds_read_b64_tr_b16 a[214:215], v35 offset:2048
    ds_read_b64_tr_b16 a[216:217], v36 offset:0
    v_mfma_f32_16x16x32_bf16 v[140:143], a[172:175], v[144:147], 0
    ds_read_b64_tr_b16 a[218:219], v36 offset:2048
    ds_read_b64_tr_b16 a[220:221], v37 offset:0
    v_mfma_f32_16x16x32_bf16 v[136:139], a[168:171], v[144:147], 0
    buffer_load_dword v9, v50, s[28:31], 0 offen sc1
    v_mfma_f32_16x16x32_bf16 v[132:135], a[164:167], v[144:147], 0
    ds_read_b64_tr_b16 a[222:223], v37 offset:2048
    v_add_u32 v1, s53, v47
    v_mfma_f32_16x16x32_bf16 v[128:131], a[160:163], v[144:147], 0
    v_xor_b32 v2, 4096, v1
    v_xor_b32 v3, 8192, v1
    v_mfma_f32_16x16x32_bf16 v[144:147], a[160:163], v[160:163], 0
    buffer_load_dwordx4 v18, s[24:27], s45 offen offset:1024 lds
    v_mfma_f32_16x16x32_bf16 v[148:151], a[164:167], v[160:163], 0
    v_xor_b32 v4, 12288, v1
    v_add_u32 v1, 77824, v1
    v_mfma_f32_16x16x32_bf16 v[152:155], a[168:171], v[160:163], 0
    v_add_u32 v2, 77824, v2
    v_add_u32 v3, 77824, v3
    v_mfma_f32_16x16x32_bf16 v[156:159], a[172:175], v[160:163], 0
    buffer_load_dwordx4 v19, s[24:27], s45 offen offset:2048 lds
    v_mfma_f32_16x16x32_bf16 v[172:175], a[172:175], v[176:179], 0
    v_add_u32 v4, 77824, v4
    v_mfma_f32_16x16x32_bf16 v[168:171], a[168:171], v[176:179], 0
    v_mfma_f32_16x16x32_bf16 v[164:167], a[164:167], v[176:179], 0
    buffer_load_dwordx4 v17, s[24:27], s45 offen offset:3072 lds
    v_mfma_f32_16x16x32_bf16 v[160:163], a[160:163], v[176:179], 0
    s_add_u32 m0, s53, 110592
    v_mfma_f32_16x16x32_bf16 v[176:179], a[160:163], v[192:195], 0
    s_mul_i32 s45, s76, 49
    v_mfma_f32_16x16x32_bf16 v[180:183], a[164:167], v[192:195], 0
    s_lshr_b32 s45, s45, 1
    v_mfma_f32_16x16x32_bf16 v[184:187], a[168:171], v[192:195], 0
    s_add_u32 s76, s76, 57344
    v_mfma_f32_16x16x32_bf16 v[188:191], a[172:175], v[192:195], 0
    v_mfma_f32_16x16x32_bf16 v[204:207], a[172:175], v[208:211], 0
    buffer_load_dwordx4 v14, s[24:27], s45 offen offset:0 lds
    v_mfma_f32_16x16x32_bf16 v[200:203], a[168:171], v[208:211], 0
    v_mfma_f32_16x16x32_bf16 v[196:199], a[164:167], v[208:211], 0
    v_mfma_f32_16x16x32_bf16 v[192:195], a[160:163], v[208:211], 0
    buffer_load_dwordx4 v18, s[24:27], s45 offen offset:1024 lds
    buffer_load_dwordx4 v19, s[24:27], s45 offen offset:2048 lds
    buffer_load_dwordx4 v17, s[24:27], s45 offen offset:3072 lds
    s_waitcnt vmcnt(13)
    s_add_u32 s59, s59, 93184
    s_mov_b64 exec, 0xffff
    buffer_store_dword v54, v49, s[28:31], s59 offen sc1
    s_mov_b64 exec, -1
    s_waitcnt lgkmcnt(0)
    s_waitcnt vmcnt(8)
    v_cmp_ne_u32 vcc, 1, v9
    s_cbranch_vccnz L_slow_4
L_ok_6:
    buffer_load_dwordx4 a[16:19], v42, s[16:19], s67 offen sc1
    buffer_load_dwordx4 a[20:23], v43, s[16:19], s67 offen sc1
    buffer_load_dwordx4 a[24:27], v44, s[16:19], s67 offen sc1
    buffer_load_dwordx4 a[28:31], v45, s[16:19], s67 offen sc1
    buffer_load_dwordx4 a[32:35], v46, s[16:19], s67 offen sc1
    buffer_load_dwordx4 a[36:39], v42, s[16:19], s68 offen sc1
    ds_read_b64_tr_b16 a[224:225], v34 offset:16384
    ds_read_b64_tr_b16 a[226:227], v34 offset:18432
    ds_read_b64_tr_b16 a[228:229], v35 offset:16384
    ds_read_b64_tr_b16 a[230:231], v35 offset:18432
    ds_read_b64_tr_b16 a[232:233], v36 offset:16384
    ds_read_b64_tr_b16 a[234:235], v36 offset:18432
    ds_read_b64_tr_b16 a[236:237], v37 offset:16384
    ds_read_b64_tr_b16 a[238:239], v37 offset:18432
    s_waitcnt vmcnt(11)
    ds_read_b64_tr_b16 a[240:241], v30 offset:20480
    ds_read_b64_tr_b16 a[242:243], v30 offset:22528
    ds_read_b64_tr_b16 a[244:245], v31 offset:20480
    ds_read_b64_tr_b16 a[246:247], v31 offset:22528
    ds_read_b64_tr_b16 a[248:249], v32 offset:20480
    ds_read_b64_tr_b16 a[250:251], v32 offset:22528
    ds_read_b64_tr_b16 a[252:253], v33 offset:20480
    ds_read_b64_tr_b16 a[254:255], v33 offset:22528
    s_waitcnt vmcnt(7)
    ds_read_b64_tr_b16 a[0:1], v34 offset:32768
    ds_read_b64_tr_b16 a[2:3], v34 offset:34816
    ds_read_b64_tr_b16 a[4:5], v35 offset:32768
    ds_read_b64_tr_b16 a[6:7], v35 offset:34816
    ds_read_b64_tr_b16 a[8:9], v36 offset:32768
    ds_read_b64_tr_b16 a[10:11], v36 offset:34816
    ds_read_b64_tr_b16 a[12:13], v37 offset:32768
    ds_read_b64_tr_b16 a[14:15], v37 offset:34816
    buffer_load_dwordx4 a[40:43], v43, s[16:19], s68 offen sc1
    buffer_load_dwordx4 a[44:47], v44, s[16:19], s68 offen sc1
    buffer_load_dwordx4 a[48:51], v45, s[16:19], s68 offen sc1
    buffer_load_dwordx4 a[52:55], v46, s[16:19], s68 offen sc1
    s_waitcnt lgkmcnt(0)
    s_mov_b32 s3, 0xffff0000
    s_waitcnt vmcnt(9)
    v_mfma_f32_16x16x32_bf16 v[224:227], a[96:99], a[16:19], v[224:227]
    buffer_load_dwordx4 a[56:59], v42, s[16:19], s69 offen sc1
    v_mfma_f32_16x16x32_bf16 v[228:231], a[100:103], a[16:19], v[228:231]
    s_mul_i32 s48, s40, 5120
    s_and_b32 s49, s40, 1
    v_mfma_f32_16x16x32_bf16 v[232:235], a[104:107], a[16:19], v[232:235]
    s_lshl_b32 s50, s49, 7
    s_add_u32 s48, s48, s50
    v_mfma_f32_16x16x32_bf16 v[236:239], a[108:111], a[16:19], v[236:239]
    v_and_b32 v20, 32, v0
    s_waitcnt vmcnt(9)
    v_mfma_f32_16x16x32_bf16 v[76:79], a[108:111], a[20:23], v[76:79]
    buffer_load_dwordx4 a[60:63], v42, s[16:19], s70 offen sc1
    v_mfma_f32_16x16x32_bf16 v[72:75], a[104:107], a[20:23], v[72:75]
    v_lshlrev_b32 v20, 1, v20
    v_xor_b32 v20, v20, v47
    v_mfma_f32_16x16x32_bf16 v[68:71], a[100:103], a[20:23], v[68:71]
    v_xor_b32 v5, s48, v20
    v_xor_b32 v6, 1152, v5
    v_mfma_f32_16x16x32_bf16 v[64:67], a[96:99], a[20:23], v[64:67]
    v_xor_b32 v7, 2048, v5
    s_waitcnt vmcnt(9)
    v_mfma_f32_16x16x32_bf16 v[80:83], a[96:99], a[24:27], v[80:83]
    buffer_load_dwordx4 a[64:67], v42, s[16:19], s71 offen sc1
    v_mfma_f32_16x16x32_bf16 v[84:87], a[100:103], a[24:27], v[84:87]
    v_xor_b32 v8, 3200, v5
    v_add_u32 v248, 143360, v5
    v_mfma_f32_16x16x32_bf16 v[88:91], a[104:107], a[24:27], v[88:91]
    v_add_u32 v249, 143360, v6
    v_add_u32 v250, 143360, v7
    v_mfma_f32_16x16x32_bf16 v[92:95], a[108:111], a[24:27], v[92:95]
    v_add_u32 v251, 143360, v8
    s_waitcnt vmcnt(9)
    v_mfma_f32_16x16x32_bf16 v[108:111], a[108:111], a[28:31], v[108:111]
    buffer_load_dwordx4 a[68:71], v42, s[16:19], s72 offen sc1
    v_mfma_f32_16x16x32_bf16 v[104:107], a[104:107], a[28:31], v[104:107]
    v_and_b32 v20, 3, v0
    v_lshlrev_b32 v20, 2, v20
    v_mfma_f32_16x16x32_bf16 v[100:103], a[100:103], a[28:31], v[100:103]
    s_lshl_b32 s49, s49, 3
    v_xor_b32 v20, v20, v24
    v_mfma_f32_16x16x32_bf16 v[96:99], a[96:99], a[28:31], v[96:99]
    v_xor_b32 v20, s49, v20
    s_waitcnt vmcnt(9)
    v_mfma_f32_16x16x32_bf16 v[112:115], a[96:99], a[32:35], v[112:115]
    buffer_load_dwordx4 a[72:75], v43, s[16:19], s69 offen sc1
    v_mfma_f32_16x16x32_bf16 v[116:119], a[100:103], a[32:35], v[116:119]
    v_lshlrev_b32 v21, 9, v26
    v_lshl_add_u32 v20, v20, 4, v21
    v_mfma_f32_16x16x32_bf16 v[120:123], a[104:107], a[32:35], v[120:123]
    s_lshr_b32 s48, s40, 1
    s_mul_i32 s48, s48, 20480
    v_mfma_f32_16x16x32_bf16 v[124:127], a[108:111], a[32:35], v[124:127]
    v_add_u32 v245, s48, v20
    s_waitcnt vmcnt(9)
    v_mfma_f32_16x16x32_bf16 v[224:227], a[112:115], a[36:39], v[224:227]
    buffer_load_dwordx4 a[76:79], v43, s[16:19], s70 offen sc1
    v_mfma_f32_16x16x32_bf16 v[228:231], a[116:119], a[36:39], v[228:231]
    s_lshl_b32 s48, s40, 2
    v_add_u32 v23, s48, v25
    v_mfma_f32_16x16x32_bf16 v[232:235], a[120:123], a[36:39], v[232:235]
    v_and_b32 v20, 6, v0
    v_lshlrev_b32 v20, 1, v20
    v_mfma_f32_16x16x32_bf16 v[236:239], a[124:127], a[36:39], v[236:239]
    v_xor_b32 v20, v20, v23
    s_waitcnt vmcnt(9)
    v_mfma_f32_16x16x32_bf16 v[76:79], a[124:127], a[40:43], v[76:79]
    buffer_load_dword v12, v51, s[28:31], 0 offen sc1
    v_mfma_f32_16x16x32_bf16 v[72:75], a[120:123], a[40:43], v[72:75]
    v_and_b32 v21, 15, v0
    v_lshlrev_b32 v20, 4, v20
    v_mfma_f32_16x16x32_bf16 v[68:71], a[116:119], a[40:43], v[68:71]
    buffer_load_dwordx4 a[80:83], v43, s[16:19], s71 offen sc1
    v_mfma_f32_16x16x32_bf16 v[64:67], a[112:115], a[40:43], v[64:67]
    v_lshl_add_u32 v20, v21, 8, v20
    s_waitcnt vmcnt(10)
    v_mfma_f32_16x16x32_bf16 v[80:83], a[112:115], a[44:47], v[80:83]
    buffer_load_dwordx4 a[84:87], v43, s[16:19], s72 offen sc1
    v_mfma_f32_16x16x32_bf16 v[84:87], a[116:119], a[44:47], v[84:87]
    v_add_u32 v246, 143360, v20
    v_mul_u32_u24 v23, 896, v23
    v_mfma_f32_16x16x32_bf16 v[88:91], a[120:123], a[44:47], v[88:91]
    v_lshl_add_u32 v23, v21, 3, v23
    s_lshl_b32 s48, s40, 3
    v_mfma_f32_16x16x32_bf16 v[92:95], a[124:127], a[44:47], v[92:95]
    v_add_u32 v62, s48, v24
    s_waitcnt vmcnt(10)
    v_mfma_f32_16x16x32_bf16 v[108:111], a[124:127], a[48:51], v[108:111]
    buffer_load_dwordx4 a[88:91], v44, s[16:19], s69 offen sc1
    v_mfma_f32_16x16x32_bf16 v[104:107], a[120:123], a[48:51], v[104:107]
    v_mul_u32_u24 v62, 896, v62
    v_lshl_add_u32 v62, v26, 4, v62
    v_mfma_f32_16x16x32_bf16 v[100:103], a[116:119], a[48:51], v[100:103]
    v_mfma_f32_16x16x32_bf16 v[96:99], a[112:115], a[48:51], v[96:99]
    s_waitcnt vmcnt(10)
    v_mfma_f32_16x16x32_bf16 v[112:115], a[112:115], a[52:55], v[112:115]
    buffer_load_dwordx4 a[92:95], v44, s[16:19], s70 offen sc1
    v_mfma_f32_16x16x32_bf16 v[116:119], a[116:119], a[52:55], v[116:119]
    v_mfma_f32_16x16x32_bf16 v[120:123], a[120:123], a[52:55], v[120:123]
    v_mfma_f32_16x16x32_bf16 v[124:127], a[124:127], a[52:55], v[124:127]
    s_waitcnt vmcnt(10)
    v_mfma_f32_16x16x32_bf16 v[224:227], a[176:179], a[56:59], v[224:227]
    buffer_load_dwordx4 a[16:19], v44, s[16:19], s71 offen sc1
    v_mfma_f32_16x16x32_bf16 v[228:231], a[180:183], a[56:59], v[228:231]
    v_mfma_f32_16x16x32_bf16 v[232:235], a[184:187], a[56:59], v[232:235]
    v_mfma_f32_16x16x32_bf16 v[236:239], a[188:191], a[56:59], v[236:239]
    s_waitcnt vmcnt(10)
    v_mfma_f32_16x16x32_bf16 v[224:227], a[192:195], a[60:63], v[224:227]
    buffer_load_dwordx4 a[20:23], v44, s[16:19], s72 offen sc1
    v_mfma_f32_16x16x32_bf16 v[228:231], a[196:199], a[60:63], v[228:231]
    v_mfma_f32_16x16x32_bf16 v[232:235], a[200:203], a[60:63], v[232:235]
    v_mfma_f32_16x16x32_bf16 v[236:239], a[204:207], a[60:63], v[236:239]
    s_waitcnt vmcnt(10)
    v_mfma_f32_16x16x32_bf16 v[224:227], a[208:211], a[64:67], v[224:227]
    buffer_load_dwordx4 a[24:27], v45, s[16:19], s69 offen sc1
    v_mfma_f32_16x16x32_bf16 v[228:231], a[212:215], a[64:67], v[228:231]
    v_mfma_f32_16x16x32_bf16 v[232:235], a[216:219], a[64:67], v[232:235]
    v_mfma_f32_16x16x32_bf16 v[236:239], a[220:223], a[64:67], v[236:239]
    s_waitcnt vmcnt(10)
    v_mfma_f32_16x16x32_bf16 v[224:227], a[224:227], a[68:71], v[224:227]
    buffer_load_dwordx4 a[28:31], v45, s[16:19], s70 offen sc1
    v_mfma_f32_16x16x32_bf16 v[228:231], a[228:231], a[68:71], v[228:231]
    v_mfma_f32_16x16x32_bf16 v[232:235], a[232:235], a[68:71], v[232:235]
    v_mfma_f32_16x16x32_bf16 v[236:239], a[236:239], a[68:71], v[236:239]
    s_waitcnt vmcnt(10)
    v_mfma_f32_16x16x32_bf16 v[76:79], a[188:191], a[72:75], v[76:79]
    buffer_load_dwordx4 a[32:35], v45, s[16:19], s71 offen sc1
    v_mfma_f32_16x16x32_bf16 v[72:75], a[184:187], a[72:75], v[72:75]
    v_mfma_f32_16x16x32_bf16 v[68:71], a[180:183], a[72:75], v[68:71]
    v_mfma_f32_16x16x32_bf16 v[64:67], a[176:179], a[72:75], v[64:67]
    ds_write_b128 v1, v[228:231] offset:0
    s_waitcnt vmcnt(10)
    v_mfma_f32_16x16x32_bf16 v[76:79], a[204:207], a[76:79], v[76:79]
    buffer_load_dwordx4 a[36:39], v45, s[16:19], s72 offen sc1
    v_mfma_f32_16x16x32_bf16 v[72:75], a[200:203], a[76:79], v[72:75]
    v_mfma_f32_16x16x32_bf16 v[68:71], a[196:199], a[76:79], v[68:71]
    ds_write_b128 v1, v[232:235] offset:1024
    v_mfma_f32_16x16x32_bf16 v[64:67], a[192:195], a[76:79], v[64:67]
    s_waitcnt vmcnt(9)
    v_mfma_f32_16x16x32_bf16 v[76:79], a[220:223], a[80:83], v[76:79]
    buffer_load_dwordx4 a[40:43], v46, s[16:19], s69 offen sc1
    v_mfma_f32_16x16x32_bf16 v[72:75], a[216:219], a[80:83], v[72:75]
    ds_write_b128 v1, v[236:239] offset:2048
    v_mfma_f32_16x16x32_bf16 v[68:71], a[212:215], a[80:83], v[68:71]
    v_mfma_f32_16x16x32_bf16 v[64:67], a[208:211], a[80:83], v[64:67]
    s_waitcnt vmcnt(9)
    v_mfma_f32_16x16x32_bf16 v[76:79], a[236:239], a[84:87], v[76:79]
    buffer_load_dwordx4 a[44:47], v46, s[16:19], s70 offen sc1
    v_mfma_f32_16x16x32_bf16 v[72:75], a[232:235], a[84:87], v[72:75]
    v_mfma_f32_16x16x32_bf16 v[68:71], a[228:231], a[84:87], v[68:71]
    v_mfma_f32_16x16x32_bf16 v[64:67], a[224:227], a[84:87], v[64:67]
    s_waitcnt vmcnt(9)
    v_mfma_f32_16x16x32_bf16 v[80:83], a[176:179], a[88:91], v[80:83]
    buffer_load_dwordx4 a[48:51], v46, s[16:19], s71 offen sc1
    v_mfma_f32_16x16x32_bf16 v[84:87], a[180:183], a[88:91], v[84:87]
    v_mfma_f32_16x16x32_bf16 v[88:91], a[184:187], a[88:91], v[88:91]
    v_mfma_f32_16x16x32_bf16 v[92:95], a[188:191], a[88:91], v[92:95]
    ds_write_b128 v1, v[68:71] offset:3072
    s_waitcnt vmcnt(9)
    v_mfma_f32_16x16x32_bf16 v[80:83], a[192:195], a[92:95], v[80:83]
    buffer_load_dwordx4 a[52:55], v46, s[16:19], s72 offen sc1
    v_mfma_f32_16x16x32_bf16 v[84:87], a[196:199], a[92:95], v[84:87]
    v_mfma_f32_16x16x32_bf16 v[88:91], a[200:203], a[92:95], v[88:91]
    ds_write_b128 v1, v[72:75] offset:16384
    v_mfma_f32_16x16x32_bf16 v[92:95], a[204:207], a[92:95], v[92:95]
    s_waitcnt vmcnt(9)
    v_cmp_ne_u32 vcc, 1, v12
    s_cbranch_vccnz L_slow_7
L_ok_9:
    v_mfma_f32_16x16x32_bf16 v[80:83], a[208:211], a[16:19], v[80:83]
    buffer_load_dwordx4 a[56:59], v240, s[16:19], s67 offen sc1
    v_mfma_f32_16x16x32_bf16 v[84:87], a[212:215], a[16:19], v[84:87]
    ds_write_b128 v1, v[76:79] offset:17408
    v_mfma_f32_16x16x32_bf16 v[88:91], a[216:219], a[16:19], v[88:91]
    v_mfma_f32_16x16x32_bf16 v[92:95], a[220:223], a[16:19], v[92:95]
    s_waitcnt vmcnt(9)
    v_mfma_f32_16x16x32_bf16 v[80:83], a[224:227], a[20:23], v[80:83]
    buffer_load_dwordx4 a[60:63], v241, s[16:19], s67 offen sc1
    v_mfma_f32_16x16x32_bf16 v[84:87], a[228:231], a[20:23], v[84:87]
    v_mfma_f32_16x16x32_bf16 v[88:91], a[232:235], a[20:23], v[88:91]
    v_mfma_f32_16x16x32_bf16 v[92:95], a[236:239], a[20:23], v[92:95]
    s_waitcnt vmcnt(9)
    v_mfma_f32_16x16x32_bf16 v[108:111], a[188:191], a[24:27], v[108:111]
    buffer_load_dwordx4 a[64:67], v242, s[16:19], s67 offen sc1
    v_mfma_f32_16x16x32_bf16 v[104:107], a[184:187], a[24:27], v[104:107]
    v_mfma_f32_16x16x32_bf16 v[100:103], a[180:183], a[24:27], v[100:103]
    v_mfma_f32_16x16x32_bf16 v[96:99], a[176:179], a[24:27], v[96:99]
    ds_write_b128 v1, v[84:87] offset:18432
    s_waitcnt vmcnt(9)
    v_mfma_f32_16x16x32_bf16 v[108:111], a[204:207], a[28:31], v[108:111]
    buffer_load_dwordx4 a[68:71], v243, s[16:19], s67 offen sc1
    v_mfma_f32_16x16x32_bf16 v[104:107], a[200:203], a[28:31], v[104:107]
    v_mfma_f32_16x16x32_bf16 v[100:103], a[196:199], a[28:31], v[100:103]
    ds_write_b128 v1, v[88:91] offset:19456
    v_mfma_f32_16x16x32_bf16 v[96:99], a[192:195], a[28:31], v[96:99]
    s_waitcnt vmcnt(9)
    v_mfma_f32_16x16x32_bf16 v[108:111], a[220:223], a[32:35], v[108:111]
    buffer_load_dwordx4 a[72:75], v244, s[16:19], s67 offen sc1
    v_mfma_f32_16x16x32_bf16 v[104:107], a[216:219], a[32:35], v[104:107]
    ds_write_b128 v1, v[92:95] offset:32768
    v_mfma_f32_16x16x32_bf16 v[100:103], a[212:215], a[32:35], v[100:103]
    v_mfma_f32_16x16x32_bf16 v[96:99], a[208:211], a[32:35], v[96:99]
    s_waitcnt vmcnt(9)
    v_mfma_f32_16x16x32_bf16 v[108:111], a[236:239], a[36:39], v[108:111]
    buffer_load_dwordx4 a[76:79], v240, s[16:19], s68 offen sc1
    v_mfma_f32_16x16x32_bf16 v[104:107], a[232:235], a[36:39], v[104:107]
    v_mfma_f32_16x16x32_bf16 v[100:103], a[228:231], a[36:39], v[100:103]
    v_mfma_f32_16x16x32_bf16 v[96:99], a[224:227], a[36:39], v[96:99]
    s_waitcnt vmcnt(9)
    v_mfma_f32_16x16x32_bf16 v[112:115], a[176:179], a[40:43], v[112:115]
    buffer_load_dwordx4 a[80:83], v241, s[16:19], s68 offen sc1
    v_mfma_f32_16x16x32_bf16 v[116:119], a[180:183], a[40:43], v[116:119]
    v_mfma_f32_16x16x32_bf16 v[120:123], a[184:187], a[40:43], v[120:123]
    v_mfma_f32_16x16x32_bf16 v[124:127], a[188:191], a[40:43], v[124:127]
    ds_write_b128 v1, v[100:103] offset:33792
    s_waitcnt vmcnt(9)
    v_mfma_f32_16x16x32_bf16 v[112:115], a[192:195], a[44:47], v[112:115]
    buffer_load_dwordx4 a[84:87], v242, s[16:19], s68 offen sc1
    v_mfma_f32_16x16x32_bf16 v[116:119], a[196:199], a[44:47], v[116:119]
    v_mfma_f32_16x16x32_bf16 v[120:123], a[200:203], a[44:47], v[120:123]
    ds_write_b128 v1, v[104:107] offset:34816
    v_mfma_f32_16x16x32_bf16 v[124:127], a[204:207], a[44:47], v[124:127]
    s_waitcnt vmcnt(9)
    v_mfma_f32_16x16x32_bf16 v[112:115], a[208:211], a[48:51], v[112:115]
    buffer_load_dwordx4 a[88:91], v243, s[16:19], s68 offen sc1
    v_mfma_f32_16x16x32_bf16 v[116:119], a[212:215], a[48:51], v[116:119]
    ds_write_b128 v1, v[108:111] offset:35840
    v_mfma_f32_16x16x32_bf16 v[120:123], a[216:219], a[48:51], v[120:123]
    v_mfma_f32_16x16x32_bf16 v[124:127], a[220:223], a[48:51], v[124:127]
    s_waitcnt vmcnt(9)
    v_mfma_f32_16x16x32_bf16 v[112:115], a[224:227], a[52:55], v[112:115]
    buffer_load_dwordx4 a[92:95], v244, s[16:19], s68 offen sc1
    v_mfma_f32_16x16x32_bf16 v[116:119], a[228:231], a[52:55], v[116:119]
    v_mfma_f32_16x16x32_bf16 v[120:123], a[232:235], a[52:55], v[120:123]
    v_mfma_f32_16x16x32_bf16 v[124:127], a[236:239], a[52:55], v[124:127]
    s_waitcnt vmcnt(9)
    v_mfma_f32_16x16x32_bf16 v[128:131], a[96:99], a[56:59], v[128:131]
    buffer_load_dwordx4 a[16:19], v240, s[16:19], s69 offen sc1
    v_mfma_f32_16x16x32_bf16 v[132:135], a[100:103], a[56:59], v[132:135]
    v_mfma_f32_16x16x32_bf16 v[136:139], a[104:107], a[56:59], v[136:139]
    v_mfma_f32_16x16x32_bf16 v[140:143], a[108:111], a[56:59], v[140:143]
    ds_write_b128 v1, v[116:119] offset:49152
    s_waitcnt vmcnt(9)
    v_mfma_f32_16x16x32_bf16 v[156:159], a[108:111], a[60:63], v[156:159]
    buffer_load_dwordx4 a[20:23], v241, s[16:19], s69 offen sc1
    v_mfma_f32_16x16x32_bf16 v[152:155], a[104:107], a[60:63], v[152:155]
    v_mfma_f32_16x16x32_bf16 v[148:151], a[100:103], a[60:63], v[148:151]
    ds_write_b128 v1, v[120:123] offset:50176
    v_mfma_f32_16x16x32_bf16 v[144:147], a[96:99], a[60:63], v[144:147]
    s_waitcnt vmcnt(9)
    v_mfma_f32_16x16x32_bf16 v[160:163], a[96:99], a[64:67], v[160:163]
    buffer_load_dwordx4 a[24:27], v242, s[16:19], s69 offen sc1
    v_mfma_f32_16x16x32_bf16 v[164:167], a[100:103], a[64:67], v[164:167]
    ds_write_b128 v1, v[124:127] offset:51200
    v_mfma_f32_16x16x32_bf16 v[168:171], a[104:107], a[64:67], v[168:171]
    v_mfma_f32_16x16x32_bf16 v[172:175], a[108:111], a[64:67], v[172:175]
    s_waitcnt vmcnt(9)
    v_mfma_f32_16x16x32_bf16 v[188:191], a[108:111], a[68:71], v[188:191]
    buffer_load_dwordx4 a[28:31], v243, s[16:19], s69 offen sc1
    buffer_load_dwordx4 a[32:35], v244, s[16:19], s69 offen sc1
    buffer_load_dwordx4 a[36:39], v240, s[16:19], s70 offen sc1
    buffer_load_dwordx4 a[40:43], v241, s[16:19], s70 offen sc1
    buffer_load_dwordx4 a[44:47], v242, s[16:19], s70 offen sc1
    buffer_load_dwordx4 a[48:51], v243, s[16:19], s70 offen sc1
    v_mfma_f32_16x16x32_bf16 v[184:187], a[104:107], a[68:71], v[184:187]
    s_waitcnt lgkmcnt(0)
    s_barrier
    ds_read_b128 v[228:231], v2 offset:0
    ds_read_b128 v[232:235], v3 offset:1024
    v_mfma_f32_16x16x32_bf16 v[180:183], a[100:103], a[68:71], v[180:183]
    ds_read_b128 v[236:239], v4 offset:2048
    ds_read_b128 v[68:71], v2 offset:3072
    ds_read_b128 v[72:75], v3 offset:16384
    v_mfma_f32_16x16x32_bf16 v[176:179], a[96:99], a[68:71], v[176:179]
    ds_read_b128 v[76:79], v4 offset:17408
    ds_read_b128 v[84:87], v2 offset:18432
    s_waitcnt vmcnt(14)
    v_mfma_f32_16x16x32_bf16 v[192:195], a[96:99], a[72:75], v[192:195]
    buffer_load_dwordx4 a[52:55], v244, s[16:19], s70 offen sc1
    ds_read_b128 v[88:91], v3 offset:19456
    v_mfma_f32_16x16x32_bf16 v[196:199], a[100:103], a[72:75], v[196:199]
    ds_read_b128 v[92:95], v4 offset:32768
    ds_read_b128 v[100:103], v2 offset:33792
    ds_read_b128 v[104:107], v3 offset:34816
    v_mfma_f32_16x16x32_bf16 v[200:203], a[104:107], a[72:75], v[200:203]
    ds_read_b128 v[108:111], v4 offset:35840
    ds_read_b128 v[116:119], v2 offset:49152
    ds_read_b128 v[120:123], v3 offset:50176
    v_mfma_f32_16x16x32_bf16 v[204:207], a[108:111], a[72:75], v[204:207]
    ds_read_b128 v[124:127], v4 offset:51200
    s_waitcnt vmcnt(14)
    v_mfma_f32_16x16x32_bf16 v[128:131], a[112:115], a[76:79], v[128:131]
    buffer_load_dwordx4 a[56:59], v240, s[16:19], s71 offen sc1
    v_mfma_f32_16x16x32_bf16 v[132:135], a[116:119], a[76:79], v[132:135]
    v_mfma_f32_16x16x32_bf16 v[136:139], a[120:123], a[76:79], v[136:139]
    s_waitcnt lgkmcnt(12)
    v_mfma_f32_16x16x32_bf16 v[140:143], a[124:127], a[76:79], v[140:143]
    v_add_f32 v224, v224, v228
    v_add_f32 v225, v225, v229
    s_waitcnt vmcnt(14)
    v_mfma_f32_16x16x32_bf16 v[156:159], a[124:127], a[80:83], v[156:159]
    buffer_load_dwordx4 a[60:63], v241, s[16:19], s71 offen sc1
    v_add_f32 v226, v226, v230
    v_mfma_f32_16x16x32_bf16 v[152:155], a[120:123], a[80:83], v[152:155]
    v_add_f32 v227, v227, v231
    v_add_f32 v232, v232, v236
    v_add_f32 v233, v233, v237
    v_mfma_f32_16x16x32_bf16 v[148:151], a[116:119], a[80:83], v[148:151]
    v_add_f32 v234, v234, v238
    v_add_f32 v235, v235, v239
    v_add_f32 v224, v224, v232
    v_mfma_f32_16x16x32_bf16 v[144:147], a[112:115], a[80:83], v[144:147]
    v_add_f32 v225, v225, v233
    v_add_f32 v226, v226, v234
    s_waitcnt vmcnt(14)
    v_mfma_f32_16x16x32_bf16 v[160:163], a[112:115], a[84:87], v[160:163]
    buffer_load_dwordx4 a[64:67], v242, s[16:19], s71 offen sc1
    v_add_f32 v227, v227, v235
    v_mfma_f32_16x16x32_bf16 v[164:167], a[116:119], a[84:87], v[164:167]
    v_cvt_pk_bf16_f32 v208, v224, v225
    v_cvt_pk_bf16_f32 v209, v226, v227
    s_waitcnt lgkmcnt(9)
    v_mfma_f32_16x16x32_bf16 v[168:171], a[120:123], a[84:87], v[168:171]
    v_add_f32 v64, v64, v68
    v_add_f32 v65, v65, v69
    v_add_f32 v66, v66, v70
    v_mfma_f32_16x16x32_bf16 v[172:175], a[124:127], a[84:87], v[172:175]
    v_add_f32 v67, v67, v71
    v_add_f32 v72, v72, v76
    s_waitcnt vmcnt(14)
    v_mfma_f32_16x16x32_bf16 v[188:191], a[124:127], a[88:91], v[188:191]
    buffer_load_dword v53, v52, s[28:31], 0 offen sc1
    v_add_f32 v73, v73, v77
    v_mfma_f32_16x16x32_bf16 v[184:187], a[120:123], a[88:91], v[184:187]
    v_add_f32 v74, v74, v78
    v_add_f32 v75, v75, v79
    v_add_f32 v64, v64, v72
    v_mfma_f32_16x16x32_bf16 v[180:183], a[116:119], a[88:91], v[180:183]
    buffer_load_dwordx4 a[68:71], v243, s[16:19], s71 offen sc1
    v_add_f32 v65, v65, v73
    v_mfma_f32_16x16x32_bf16 v[176:179], a[112:115], a[88:91], v[176:179]
    v_add_f32 v66, v66, v74
    v_add_f32 v67, v67, v75
    s_waitcnt vmcnt(15)
    v_mfma_f32_16x16x32_bf16 v[192:195], a[112:115], a[92:95], v[192:195]
    buffer_load_dwordx4 a[72:75], v244, s[16:19], s71 offen sc1
    v_cvt_pk_bf16_f32 v210, v64, v65
    v_mfma_f32_16x16x32_bf16 v[196:199], a[116:119], a[92:95], v[196:199]
    v_cvt_pk_bf16_f32 v211, v66, v67
    v_mfma_f32_16x16x32_bf16 v[200:203], a[120:123], a[92:95], v[200:203]
    buffer_store_dwordx4 v[208:211], v47, s[28:31], s58 offen offset:0 sc1
    v_mfma_f32_16x16x32_bf16 v[204:207], a[124:127], a[92:95], v[204:207]
    s_waitcnt lgkmcnt(6)
    v_add_f32 v80, v80, v84
    s_waitcnt vmcnt(16)
    v_mfma_f32_16x16x32_bf16 v[128:131], a[176:179], a[16:19], v[128:131]
    buffer_load_dwordx4 a[76:79], v240, s[16:19], s72 offen sc1
L_pad_ffn_3:
    s_cbranch_execz L_ret_ffn
    v_add_f32 v81, v81, v85
    v_mfma_f32_16x16x32_bf16 v[132:135], a[180:183], a[16:19], v[132:135]
    v_add_f32 v82, v82, v86
    v_add_f32 v83, v83, v87
    v_add_f32 v88, v88, v92
    v_mfma_f32_16x16x32_bf16 v[136:139], a[184:187], a[16:19], v[136:139]
    v_add_f32 v89, v89, v93
    v_add_f32 v90, v90, v94
    v_add_f32 v91, v91, v95
    v_mfma_f32_16x16x32_bf16 v[140:143], a[188:191], a[16:19], v[140:143]
    v_add_f32 v80, v80, v88
    v_add_f32 v81, v81, v89
    s_waitcnt vmcnt(16)
    v_mfma_f32_16x16x32_bf16 v[156:159], a[188:191], a[20:23], v[156:159]
    buffer_load_dwordx4 a[80:83], v241, s[16:19], s72 offen sc1
    v_add_f32 v82, v82, v90
    v_mfma_f32_16x16x32_bf16 v[152:155], a[184:187], a[20:23], v[152:155]
    v_add_f32 v83, v83, v91
    v_cvt_pk_bf16_f32 v212, v80, v81
    v_cvt_pk_bf16_f32 v213, v82, v83
    v_mfma_f32_16x16x32_bf16 v[148:151], a[180:183], a[20:23], v[148:151]
    s_waitcnt lgkmcnt(3)
    v_add_f32 v96, v96, v100
    v_add_f32 v97, v97, v101
    v_mfma_f32_16x16x32_bf16 v[144:147], a[176:179], a[20:23], v[144:147]
    v_add_f32 v98, v98, v102
    v_add_f32 v99, v99, v103
    s_waitcnt vmcnt(16)
    v_mfma_f32_16x16x32_bf16 v[160:163], a[176:179], a[24:27], v[160:163]
    buffer_load_dwordx4 a[84:87], v242, s[16:19], s72 offen sc1
    v_add_f32 v104, v104, v108
    v_mfma_f32_16x16x32_bf16 v[164:167], a[180:183], a[24:27], v[164:167]
    v_add_f32 v105, v105, v109
    v_add_f32 v106, v106, v110
    v_add_f32 v107, v107, v111
    v_mfma_f32_16x16x32_bf16 v[168:171], a[184:187], a[24:27], v[168:171]
    v_add_f32 v96, v96, v104
    v_add_f32 v97, v97, v105
    v_add_f32 v98, v98, v106
    v_mfma_f32_16x16x32_bf16 v[172:175], a[188:191], a[24:27], v[172:175]
    v_add_f32 v99, v99, v107
    v_cvt_pk_bf16_f32 v214, v96, v97
    s_waitcnt vmcnt(16)
    v_mfma_f32_16x16x32_bf16 v[188:191], a[188:191], a[28:31], v[188:191]
    buffer_load_dwordx4 a[88:91], v243, s[16:19], s72 offen sc1
    v_cvt_pk_bf16_f32 v215, v98, v99
    v_mfma_f32_16x16x32_bf16 v[184:187], a[184:187], a[28:31], v[184:187]
    buffer_store_dwordx4 v[212:215], v47, s[28:31], s58 offen offset:1024 sc1
    v_mfma_f32_16x16x32_bf16 v[180:183], a[180:183], a[28:31], v[180:183]
    s_waitcnt lgkmcnt(0)
    v_add_f32 v112, v112, v116
    v_add_f32 v113, v113, v117
    v_mfma_f32_16x16x32_bf16 v[176:179], a[176:179], a[28:31], v[176:179]
    v_add_f32 v114, v114, v118
    v_add_f32 v115, v115, v119
    s_waitcnt vmcnt(17)
    v_mfma_f32_16x16x32_bf16 v[192:195], a[176:179], a[32:35], v[192:195]
    buffer_load_dwordx4 a[92:95], v244, s[16:19], s72 offen sc1
    v_add_f32 v120, v120, v124
    v_mfma_f32_16x16x32_bf16 v[196:199], a[180:183], a[32:35], v[196:199]
    v_add_f32 v121, v121, v125
    v_add_f32 v122, v122, v126
    v_add_f32 v123, v123, v127
    v_mfma_f32_16x16x32_bf16 v[200:203], a[184:187], a[32:35], v[200:203]
    v_add_f32 v112, v112, v120
    v_add_f32 v113, v113, v121
    v_add_f32 v114, v114, v122
    v_mfma_f32_16x16x32_bf16 v[204:207], a[188:191], a[32:35], v[204:207]
    v_add_f32 v115, v115, v123
    v_cvt_pk_bf16_f32 v216, v112, v113
    s_waitcnt vmcnt(17)
    v_mfma_f32_16x16x32_bf16 v[128:131], a[192:195], a[36:39], v[128:131]
    buffer_load_dwordx3 v[56:58], v59, s[28:31], 0 offen sc1
    v_cvt_pk_bf16_f32 v217, v114, v115
    v_mfma_f32_16x16x32_bf16 v[132:135], a[196:199], a[36:39], v[132:135]
    buffer_store_dwordx2 v[216:217], v247, s[28:31], s58 offen offset:2048 sc1
    v_mfma_f32_16x16x32_bf16 v[136:139], a[200:203], a[36:39], v[136:139]
    v_mfma_f32_16x16x32_bf16 v[140:143], a[204:207], a[36:39], v[140:143]
    s_waitcnt vmcnt(18)
    v_mfma_f32_16x16x32_bf16 v[156:159], a[204:207], a[40:43], v[156:159]
    buffer_load_dwordx2 v[60:61], v252, s[28:31], 0 offen sc1
    v_mfma_f32_16x16x32_bf16 v[152:155], a[200:203], a[40:43], v[152:155]
    v_mfma_f32_16x16x32_bf16 v[148:151], a[196:199], a[40:43], v[148:151]
    v_mfma_f32_16x16x32_bf16 v[144:147], a[192:195], a[40:43], v[144:147]
    s_waitcnt vmcnt(18)
    v_mfma_f32_16x16x32_bf16 v[160:163], a[192:195], a[44:47], v[160:163]
    v_mfma_f32_16x16x32_bf16 v[164:167], a[196:199], a[44:47], v[164:167]
    v_mfma_f32_16x16x32_bf16 v[168:171], a[200:203], a[44:47], v[168:171]
    v_mfma_f32_16x16x32_bf16 v[172:175], a[204:207], a[44:47], v[172:175]
    s_waitcnt vmcnt(17)
    s_waitcnt vmcnt(12)
    v_cmp_ne_u32 vcc, 1, v53
    s_cbranch_vccnz L_slow_10
L_ok_12:
    v_mfma_f32_16x16x32_bf16 v[188:191], a[204:207], a[48:51], v[188:191]
    buffer_load_dwordx4 v[64:67], v240, s[16:19], s73 offen sc1
    v_mfma_f32_16x16x32_bf16 v[184:187], a[200:203], a[48:51], v[184:187]
    v_mfma_f32_16x16x32_bf16 v[180:183], a[196:199], a[48:51], v[180:183]
    buffer_load_dwordx4 v[84:87], v240, s[16:19], s74 offen sc1
    v_mfma_f32_16x16x32_bf16 v[176:179], a[192:195], a[48:51], v[176:179]
    v_mfma_f32_16x16x32_bf16 v[192:195], a[192:195], a[52:55], v[192:195]
    buffer_load_dwordx4 v[104:107], v240, s[16:19], s75 offen sc1
    v_mfma_f32_16x16x32_bf16 v[196:199], a[196:199], a[52:55], v[196:199]
    v_mfma_f32_16x16x32_bf16 v[200:203], a[200:203], a[52:55], v[200:203]
    buffer_load_dwordx4 v[124:127], v240, s[16:19], s76 offen sc1
    v_mfma_f32_16x16x32_bf16 v[204:207], a[204:207], a[52:55], v[204:207]
    v_mfma_f32_16x16x32_bf16 v[128:131], a[208:211], a[56:59], v[128:131]
    buffer_load_dwordx4 v[68:71], v241, s[16:19], s73 offen sc1
    v_mfma_f32_16x16x32_bf16 v[132:135], a[212:215], a[56:59], v[132:135]
    v_mfma_f32_16x16x32_bf16 v[136:139], a[216:219], a[56:59], v[136:139]
    v_mfma_f32_16x16x32_bf16 v[140:143], a[220:223], a[56:59], v[140:143]
    v_mfma_f32_16x16x32_bf16 v[156:159], a[220:223], a[60:63], v[156:159]
    buffer_load_dwordx4 v[88:91], v241, s[16:19], s74 offen sc1
    v_mfma_f32_16x16x32_bf16 v[152:155], a[216:219], a[60:63], v[152:155]
    v_mfma_f32_16x16x32_bf16 v[148:151], a[212:215], a[60:63], v[148:151]
    v_mfma_f32_16x16x32_bf16 v[144:147], a[208:211], a[60:63], v[144:147]
    v_mfma_f32_16x16x32_bf16 v[160:163], a[208:211], a[64:67], v[160:163]
    buffer_load_dwordx4 v[108:111], v241, s[16:19], s75 offen sc1
    v_mfma_f32_16x16x32_bf16 v[164:167], a[212:215], a[64:67], v[164:167]
    v_mfma_f32_16x16x32_bf16 v[168:171], a[216:219], a[64:67], v[168:171]
    v_mfma_f32_16x16x32_bf16 v[172:175], a[220:223], a[64:67], v[172:175]
    s_waitcnt vmcnt(18)
    v_mfma_f32_16x16x32_bf16 v[188:191], a[220:223], a[68:71], v[188:191]
    buffer_load_dwordx4 v[224:227], v241, s[16:19], s76 offen sc1
    v_mfma_f32_16x16x32_bf16 v[184:187], a[216:219], a[68:71], v[184:187]
    v_mfma_f32_16x16x32_bf16 v[180:183], a[212:215], a[68:71], v[180:183]
    v_mfma_f32_16x16x32_bf16 v[176:179], a[208:211], a[68:71], v[176:179]
    s_waitcnt vmcnt(18)
    v_mfma_f32_16x16x32_bf16 v[192:195], a[208:211], a[72:75], v[192:195]
    buffer_load_dwordx4 v[72:75], v242, s[16:19], s73 offen sc1
    v_mfma_f32_16x16x32_bf16 v[196:199], a[212:215], a[72:75], v[196:199]
    v_mfma_f32_16x16x32_bf16 v[200:203], a[216:219], a[72:75], v[200:203]
    v_mfma_f32_16x16x32_bf16 v[204:207], a[220:223], a[72:75], v[204:207]
    s_waitcnt vmcnt(17)
    v_mfma_f32_16x16x32_bf16 v[128:131], a[224:227], a[76:79], v[128:131]
    buffer_load_dwordx4 v[92:95], v242, s[16:19], s74 offen sc1
    v_mfma_f32_16x16x32_bf16 v[132:135], a[228:231], a[76:79], v[132:135]
    v_mfma_f32_16x16x32_bf16 v[136:139], a[232:235], a[76:79], v[136:139]
    v_mfma_f32_16x16x32_bf16 v[140:143], a[236:239], a[76:79], v[140:143]
    s_waitcnt vmcnt(10)
    v_max3_u32 v22, v56, v57, v58
    v_max3_u32 v22, v22, v60, v61
    v_cmp_eq_u32 vcc, -1, v22
    s_cbranch_vccnz L_slow_13
L_ok_14:
    v_mfma_f32_16x16x32_bf16 v[156:159], a[236:239], a[80:83], v[156:159]
    buffer_load_dwordx4 v[112:115], v242, s[16:19], s75 offen sc1
    v_mfma_f32_16x16x32_bf16 v[152:155], a[232:235], a[80:83], v[152:155]
    v_mfma_f32_16x16x32_bf16 v[148:151], a[228:231], a[80:83], v[148:151]
    v_mfma_f32_16x16x32_bf16 v[144:147], a[224:227], a[80:83], v[144:147]
    v_mfma_f32_16x16x32_bf16 v[160:163], a[224:227], a[84:87], v[160:163]
    buffer_load_dwordx4 v[228:231], v242, s[16:19], s76 offen sc1
    v_mfma_f32_16x16x32_bf16 v[164:167], a[228:231], a[84:87], v[164:167]
    v_mul_f32 v128, v56, v128
    v_mul_f32 v129, v56, v129
    v_mfma_f32_16x16x32_bf16 v[168:171], a[232:235], a[84:87], v[168:171]
    v_mul_f32 v130, v56, v130
    v_mul_f32 v131, v56, v131
    v_mfma_f32_16x16x32_bf16 v[172:175], a[236:239], a[84:87], v[172:175]
    v_mul_f32 v132, v56, v132
    v_mfma_f32_16x16x32_bf16 v[188:191], a[236:239], a[88:91], v[188:191]
    buffer_load_dwordx4 v[76:79], v243, s[16:19], s73 offen sc1
    v_mfma_f32_16x16x32_bf16 v[184:187], a[232:235], a[88:91], v[184:187]
    v_mul_f32 v133, v56, v133
    v_mul_f32 v134, v56, v134
    v_mfma_f32_16x16x32_bf16 v[180:183], a[228:231], a[88:91], v[180:183]
    v_mul_f32 v135, v56, v135
    v_mul_f32 v136, v56, v136
    v_mfma_f32_16x16x32_bf16 v[176:179], a[224:227], a[88:91], v[176:179]
    v_mul_f32 v137, v56, v137
    v_mfma_f32_16x16x32_bf16 v[192:195], a[224:227], a[92:95], v[192:195]
    buffer_load_dwordx4 v[96:99], v243, s[16:19], s74 offen sc1
    v_mfma_f32_16x16x32_bf16 v[196:199], a[228:231], a[92:95], v[196:199]
    s_waitcnt vmcnt(10)
    v_max3_u32 v22, v64, v65, v66
    v_mfma_f32_16x16x32_bf16 v[200:203], a[232:235], a[92:95], v[200:203]
    v_max3_u32 v22, v22, v67, v84
    v_max3_u32 v22, v22, v85, v86
    v_mfma_f32_16x16x32_bf16 v[204:207], a[236:239], a[92:95], v[204:207]
    v_max3_u32 v22, v22, v87, v104
    v_max3_u32 v22, v22, v105, v106
    v_max3_u32 v22, v22, v107, v124
    v_max3_u32 v22, v22, v125, v126
    v_max3_u32 v22, v22, v127, v127
    v_cmp_eq_u32 vcc, -1, v22
    s_cbranch_vccnz L_slow_15
L_ok_16:
    v_mul_f32 v138, v56, v138
    v_mul_f32 v139, v56, v139
    v_mul_f32 v140, v56, v140
    v_mul_f32 v141, v56, v141
    v_mul_f32 v142, v56, v142
    v_mul_f32 v143, v56, v143
    s_nop 1
    v_mfma_f32_16x16x32_bf16 v[128:131], a[128:131], v[64:67], v[128:131]
    buffer_load_dwordx4 v[116:119], v243, s[16:19], s75 offen sc1
    v_mfma_f32_16x16x32_bf16 v[132:135], a[132:135], v[64:67], v[132:135]
    v_mul_f32 v144, v57, v144
    v_mul_f32 v145, v57, v145
    v_mfma_f32_16x16x32_bf16 v[136:139], a[136:139], v[64:67], v[136:139]
    v_mul_f32 v146, v57, v146
    v_mul_f32 v147, v57, v147
    v_mfma_f32_16x16x32_bf16 v[140:143], a[140:143], v[64:67], v[140:143]
    v_mul_f32 v148, v57, v148
    v_mfma_f32_16x16x32_bf16 v[128:131], a[144:147], v[84:87], v[128:131]
    buffer_load_dwordx4 v[232:235], v243, s[16:19], s76 offen sc1
    v_mfma_f32_16x16x32_bf16 v[132:135], a[148:151], v[84:87], v[132:135]
    v_mul_f32 v149, v57, v149
    v_mul_f32 v150, v57, v150
    v_mfma_f32_16x16x32_bf16 v[136:139], a[152:155], v[84:87], v[136:139]
    v_mul_f32 v151, v57, v151
    v_mul_f32 v152, v57, v152
    v_mfma_f32_16x16x32_bf16 v[140:143], a[156:159], v[84:87], v[140:143]
    v_mul_f32 v153, v57, v153
    v_mfma_f32_16x16x32_bf16 v[128:131], a[240:243], v[104:107], v[128:131]
    buffer_load_dwordx4 v[80:83], v244, s[16:19], s73 offen sc1
    v_mfma_f32_16x16x32_bf16 v[132:135], a[244:247], v[104:107], v[132:135]
    v_mul_f32 v154, v57, v154
    v_mul_f32 v155, v57, v155
    v_mfma_f32_16x16x32_bf16 v[136:139], a[248:251], v[104:107], v[136:139]
    v_mul_f32 v156, v57, v156
    v_mul_f32 v157, v57, v157
    v_mfma_f32_16x16x32_bf16 v[140:143], a[252:255], v[104:107], v[140:143]
    v_mul_f32 v158, v57, v158
    v_mfma_f32_16x16x32_bf16 v[128:131], a[0:3], v[124:127], v[128:131]
    buffer_load_dwordx4 v[100:103], v244, s[16:19], s74 offen sc1
    v_mfma_f32_16x16x32_bf16 v[132:135], a[4:7], v[124:127], v[132:135]
    s_waitcnt vmcnt(10)
    v_max3_u32 v22, v68, v69, v70
    v_mfma_f32_16x16x32_bf16 v[136:139], a[8:11], v[124:127], v[136:139]
    v_max3_u32 v22, v22, v71, v88
    v_max3_u32 v22, v22, v89, v90
    v_mfma_f32_16x16x32_bf16 v[140:143], a[12:15], v[124:127], v[140:143]
    v_max3_u32 v22, v22, v91, v108
    v_max3_u32 v22, v22, v109, v110
    v_max3_u32 v22, v22, v111, v224
    v_max3_u32 v22, v22, v225, v226
    v_max3_u32 v22, v22, v227, v227
    v_cmp_eq_u32 vcc, -1, v22
    s_cbranch_vccnz L_slow_17
L_ok_18:
    v_mul_f32 v159, v57, v159
    s_nop 1
    v_mfma_f32_16x16x32_bf16 v[156:159], a[140:143], v[68:71], v[156:159]
    buffer_load_dwordx4 v[120:123], v244, s[16:19], s75 offen sc1
    v_mfma_f32_16x16x32_bf16 v[152:155], a[136:139], v[68:71], v[152:155]
    v_mul_f32 v160, v58, v160
    v_mul_f32 v161, v58, v161
    v_mfma_f32_16x16x32_bf16 v[148:151], a[132:135], v[68:71], v[148:151]
    buffer_load_dwordx4 v[208:211], v47, s[28:31], s54 offen offset:0 sc1
    v_mfma_f32_16x16x32_bf16 v[144:147], a[128:131], v[68:71], v[144:147]
    v_mul_f32 v162, v58, v162
    v_mfma_f32_16x16x32_bf16 v[156:159], a[156:159], v[88:91], v[156:159]
    buffer_load_dwordx4 v[236:239], v244, s[16:19], s76 offen sc1
    v_mfma_f32_16x16x32_bf16 v[152:155], a[152:155], v[88:91], v[152:155]
    ds_write_b128 v6, v[132:135] offset:0
    v_mfma_f32_16x16x32_bf16 v[148:151], a[148:151], v[88:91], v[148:151]
    buffer_load_dwordx4 v[212:215], v47, s[28:31], s54 offen offset:1024 sc1
    v_mfma_f32_16x16x32_bf16 v[144:147], a[144:147], v[88:91], v[144:147]
    v_mul_f32 v163, v58, v163
    v_mfma_f32_16x16x32_bf16 v[156:159], a[252:255], v[108:111], v[156:159]
    buffer_load_dwordx2 v[216:217], v247, s[28:31], s54 offen offset:2048 sc1
    v_mfma_f32_16x16x32_bf16 v[152:155], a[248:251], v[108:111], v[152:155]
    ds_write_b128 v7, v[136:139] offset:0
    v_mfma_f32_16x16x32_bf16 v[148:151], a[244:247], v[108:111], v[148:151]
    v_mul_f32 v164, v58, v164
    v_mul_f32 v165, v58, v165
    v_mfma_f32_16x16x32_bf16 v[144:147], a[240:243], v[108:111], v[144:147]
    v_mul_f32 v166, v58, v166
    v_mfma_f32_16x16x32_bf16 v[156:159], a[12:15], v[224:227], v[156:159]
    s_waitcnt vmcnt(11)
    v_max3_u32 v22, v72, v73, v74
    v_mfma_f32_16x16x32_bf16 v[152:155], a[8:11], v[224:227], v[152:155]
    v_max3_u32 v22, v22, v75, v92
    v_max3_u32 v22, v22, v93, v94
    v_mfma_f32_16x16x32_bf16 v[148:151], a[4:7], v[224:227], v[148:151]
    v_max3_u32 v22, v22, v95, v112
    v_max3_u32 v22, v22, v113, v114
    v_mfma_f32_16x16x32_bf16 v[144:147], a[0:3], v[224:227], v[144:147]
    v_max3_u32 v22, v22, v115, v228
    v_max3_u32 v22, v22, v229, v230
    v_max3_u32 v22, v22, v231, v231
    v_cmp_eq_u32 vcc, -1, v22
    s_cbranch_vccnz L_slow_19
L_ok_20:
    v_mul_f32 v167, v58, v167
    v_mul_f32 v168, v58, v168
    v_mul_f32 v169, v58, v169
    v_mul_f32 v170, v58, v170
    v_mul_f32 v171, v58, v171
    v_mul_f32 v172, v58, v172
    v_mul_f32 v173, v58, v173
    v_mul_f32 v174, v58, v174
    v_mul_f32 v175, v58, v175
    s_nop 1
    v_mfma_f32_16x16x32_bf16 v[160:163], a[128:131], v[72:75], v[160:163]
    v_mul_f32 v176, v60, v176
    v_mul_f32 v177, v60, v177
    v_mfma_f32_16x16x32_bf16 v[164:167], a[132:135], v[72:75], v[164:167]
    ds_write_b128 v8, v[140:143] offset:0
    v_mfma_f32_16x16x32_bf16 v[168:171], a[136:139], v[72:75], v[168:171]
    v_mul_f32 v178, v60, v178
    v_mul_f32 v179, v60, v179
    v_mfma_f32_16x16x32_bf16 v[172:175], a[140:143], v[72:75], v[172:175]
    v_mul_f32 v180, v60, v180
    v_mfma_f32_16x16x32_bf16 v[160:163], a[144:147], v[92:95], v[160:163]
    v_mul_f32 v181, v60, v181
    v_mul_f32 v182, v60, v182
    v_mfma_f32_16x16x32_bf16 v[164:167], a[148:151], v[92:95], v[164:167]
    ds_write_b128 v6, v[148:151] offset:20480
    v_mfma_f32_16x16x32_bf16 v[168:171], a[152:155], v[92:95], v[168:171]
    v_mul_f32 v183, v60, v183
    v_mul_f32 v184, v60, v184
    v_mfma_f32_16x16x32_bf16 v[172:175], a[156:159], v[92:95], v[172:175]
    v_mul_f32 v185, v60, v185
    v_mfma_f32_16x16x32_bf16 v[160:163], a[240:243], v[112:115], v[160:163]
    v_mul_f32 v186, v60, v186
    v_mul_f32 v187, v60, v187
    v_mfma_f32_16x16x32_bf16 v[164:167], a[244:247], v[112:115], v[164:167]
    ds_write_b128 v7, v[152:155] offset:20480
    v_mfma_f32_16x16x32_bf16 v[168:171], a[248:251], v[112:115], v[168:171]
    v_mul_f32 v188, v60, v188
    v_mul_f32 v189, v60, v189
    v_mfma_f32_16x16x32_bf16 v[172:175], a[252:255], v[112:115], v[172:175]
    v_mul_f32 v190, v60, v190
    v_mfma_f32_16x16x32_bf16 v[160:163], a[0:3], v[228:231], v[160:163]
    s_waitcnt vmcnt(7)
    v_max3_u32 v22, v76, v77, v78
    v_mfma_f32_16x16x32_bf16 v[164:167], a[4:7], v[228:231], v[164:167]
    v_max3_u32 v22, v22, v79, v96
    v_max3_u32 v22, v22, v97, v98
    v_mfma_f32_16x16x32_bf16 v[168:171], a[8:11], v[228:231], v[168:171]
    v_max3_u32 v22, v22, v99, v116
    v_max3_u32 v22, v22, v117, v118
    v_mfma_f32_16x16x32_bf16 v[172:175], a[12:15], v[228:231], v[172:175]
    v_max3_u32 v22, v22, v119, v232
    v_max3_u32 v22, v22, v233, v234
    v_max3_u32 v22, v22, v235, v235
    v_cmp_eq_u32 vcc, -1, v22
    s_cbranch_vccnz L_slow_21
L_ok_22:
    v_mul_f32 v191, v60, v191
    s_nop 1
    v_mfma_f32_16x16x32_bf16 v[188:191], a[140:143], v[76:79], v[188:191]
    v_mul_f32 v192, v61, v192
    v_mul_f32 v193, v61, v193
    v_mfma_f32_16x16x32_bf16 v[184:187], a[136:139], v[76:79], v[184:187]
    ds_write_b128 v8, v[156:159] offset:20480
    v_mfma_f32_16x16x32_bf16 v[180:183], a[132:135], v[76:79], v[180:183]
    v_mul_f32 v194, v61, v194
    v_mul_f32 v195, v61, v195
    v_mfma_f32_16x16x32_bf16 v[176:179], a[128:131], v[76:79], v[176:179]
    v_mul_f32 v196, v61, v196
    v_mfma_f32_16x16x32_bf16 v[188:191], a[156:159], v[96:99], v[188:191]
    v_mul_f32 v197, v61, v197
    v_mul_f32 v198, v61, v198
    v_mfma_f32_16x16x32_bf16 v[184:187], a[152:155], v[96:99], v[184:187]
    ds_write_b128 v6, v[164:167] offset:40960
    v_mfma_f32_16x16x32_bf16 v[180:183], a[148:151], v[96:99], v[180:183]
    v_mul_f32 v199, v61, v199
    v_mul_f32 v200, v61, v200
    v_mfma_f32_16x16x32_bf16 v[176:179], a[144:147], v[96:99], v[176:179]
    v_mul_f32 v201, v61, v201
    v_mfma_f32_16x16x32_bf16 v[188:191], a[252:255], v[116:119], v[188:191]
    v_mul_f32 v202, v61, v202
    v_mul_f32 v203, v61, v203
    v_mfma_f32_16x16x32_bf16 v[184:187], a[248:251], v[116:119], v[184:187]
    ds_write_b128 v7, v[168:171] offset:40960
    v_mfma_f32_16x16x32_bf16 v[180:183], a[244:247], v[116:119], v[180:183]
    v_mul_f32 v204, v61, v204
    v_mul_f32 v205, v61, v205
    v_mfma_f32_16x16x32_bf16 v[176:179], a[240:243], v[116:119], v[176:179]
    v_mul_f32 v206, v61, v206
    s_waitcnt vmcnt(0)
    v_max3_u32 v22, v208, v209, v210
    v_max3_u32 v22, v22, v211, v212
    v_max3_u32 v22, v22, v213, v214
    v_max3_u32 v22, v22, v215, v216
    v_max3_u32 v22, v22, v217, v217
    v_cmp_eq_u32 vcc, -1, v22
    s_cbranch_vccnz L_slow_23
L_ok_24:
    v_mfma_f32_16x16x32_bf16 v[188:191], a[12:15], v[232:235], v[188:191]
    v_max3_u32 v22, v80, v81, v82
    v_mfma_f32_16x16x32_bf16 v[184:187], a[8:11], v[232:235], v[184:187]
    v_max3_u32 v22, v22, v83, v100
    v_max3_u32 v22, v22, v101, v102
    v_mfma_f32_16x16x32_bf16 v[180:183], a[4:7], v[232:235], v[180:183]
    v_max3_u32 v22, v22, v103, v120
    v_max3_u32 v22, v22, v121, v122
    v_mfma_f32_16x16x32_bf16 v[176:179], a[0:3], v[232:235], v[176:179]
    v_max3_u32 v22, v22, v123, v236
    v_max3_u32 v22, v22, v237, v238
    v_max3_u32 v22, v22, v239, v239
    v_cmp_eq_u32 vcc, -1, v22
    s_cbranch_vccnz L_slow_25
L_ok_26:
    v_mul_f32 v207, v61, v207
    s_nop 1
    v_mfma_f32_16x16x32_bf16 v[192:195], a[128:131], v[80:83], v[192:195]
    v_lshlrev_b32 v24, 16, v208
    v_and_b32 v25, s3, v208
    v_mfma_f32_16x16x32_bf16 v[196:199], a[132:135], v[80:83], v[196:199]
    ds_write_b128 v8, v[172:175] offset:40960
    v_mfma_f32_16x16x32_bf16 v[200:203], a[136:139], v[80:83], v[200:203]
    v_lshlrev_b32 v26, 16, v209
    v_and_b32 v27, s3, v209
    v_mfma_f32_16x16x32_bf16 v[204:207], a[140:143], v[80:83], v[204:207]
    v_fmac_f32 v128, v56, v24
    v_mfma_f32_16x16x32_bf16 v[192:195], a[144:147], v[100:103], v[192:195]
    v_fmac_f32 v129, v56, v25
    v_fmac_f32 v130, v56, v26
    v_mfma_f32_16x16x32_bf16 v[196:199], a[148:151], v[100:103], v[196:199]
    ds_write_b128 v6, v[180:183] offset:61440
    v_mfma_f32_16x16x32_bf16 v[200:203], a[152:155], v[100:103], v[200:203]
    v_fmac_f32 v131, v56, v27
    ds_write_b128 v5, v[128:131] offset:0
    v_mfma_f32_16x16x32_bf16 v[204:207], a[156:159], v[100:103], v[204:207]
    v_lshlrev_b32 v28, 16, v210
    v_mfma_f32_16x16x32_bf16 v[192:195], a[240:243], v[120:123], v[192:195]
    v_and_b32 v29, s3, v210
    v_lshlrev_b32 v30, 16, v211
    v_mfma_f32_16x16x32_bf16 v[196:199], a[244:247], v[120:123], v[196:199]
    ds_write_b128 v7, v[184:187] offset:61440
    v_mfma_f32_16x16x32_bf16 v[200:203], a[248:251], v[120:123], v[200:203]
    v_and_b32 v31, s3, v211
    v_fmac_f32 v144, v57, v28
    v_mfma_f32_16x16x32_bf16 v[204:207], a[252:255], v[120:123], v[204:207]
    v_fmac_f32 v145, v57, v29
    v_mfma_f32_16x16x32_bf16 v[192:195], a[0:3], v[236:239], v[192:195]
    v_fmac_f32 v146, v57, v30
    v_fmac_f32 v147, v57, v31
    v_mfma_f32_16x16x32_bf16 v[196:199], a[4:7], v[236:239], v[196:199]
    ds_write_b128 v8, v[188:191] offset:61440
    v_mfma_f32_16x16x32_bf16 v[200:203], a[8:11], v[236:239], v[200:203]
    ds_write_b128 v5, v[144:147] offset:20480
    v_lshlrev_b32 v24, 16, v212
    v_mfma_f32_16x16x32_bf16 v[204:207], a[12:15], v[236:239], v[204:207]
    v_and_b32 v25, s3, v212
    v_lshlrev_b32 v26, 16, v213
    v_and_b32 v27, s3, v213
    v_fmac_f32 v160, v58, v24
    v_fmac_f32 v161, v58, v25
    v_fmac_f32 v162, v58, v26
    v_fmac_f32 v163, v58, v27
    ds_write_b128 v5, v[160:163] offset:40960
    v_lshlrev_b32 v28, 16, v214
    v_and_b32 v29, s3, v214
    v_lshlrev_b32 v30, 16, v215
    v_and_b32 v31, s3, v215
    v_fmac_f32 v176, v60, v28
    v_fmac_f32 v177, v60, v29
    v_fmac_f32 v178, v60, v30
    v_fmac_f32 v179, v60, v31
    ds_write_b128 v5, v[176:179] offset:61440
    ds_write_b128 v249, v[196:199] offset:0
    ds_write_b128 v250, v[200:203] offset:0
    ds_write_b128 v251, v[204:207] offset:0
    v_lshlrev_b32 v24, 16, v216
    v_and_b32 v25, s3, v216
    v_lshlrev_b32 v26, 16, v217
    v_and_b32 v27, s3, v217
    v_fmac_f32 v192, v61, v24
    v_fmac_f32 v193, v61, v25
    v_fmac_f32 v194, v61, v26
    v_fmac_f32 v195, v61, v27
    ds_write_b128 v248, v[192:195] offset:0
    s_waitcnt lgkmcnt(0)
    s_barrier
    ds_read_b128 v[64:67], v245 offset:0
    ds_read_b128 v[68:71], v245 offset:256
    ds_read_b128 v[72:75], v245 offset:4096
    ds_read_b128 v[76:79], v245 offset:4352
    ds_read_b128 v[80:83], v245 offset:8192
    ds_read_b128 v[84:87], v245 offset:8448
    ds_read_b128 v[88:91], v245 offset:12288
    ds_read_b128 v[92:95], v245 offset:12544
    ds_read_b128 v[96:99], v245 offset:40960
    ds_read_b128 v[100:103], v245 offset:41216
    ds_read_b128 v[104:107], v245 offset:45056
    ds_read_b128 v[108:111], v245 offset:45312
    ds_read_b128 v[112:115], v245 offset:49152
    ds_read_b128 v[116:119], v245 offset:49408
    ds_read_b128 v[120:123], v245 offset:53248
    ds_read_b128 v[124:127], v245 offset:53504
    ds_read_b128 v[224:227], v246 offset:0
    ds_read_b128 v[228:231], v246 offset:4096
    ds_read_b128 v[232:235], v246 offset:8192
    ds_read_b128 v[236:239], v246 offset:12288
    s_waitcnt lgkmcnt(15)
    v_pk_add_f32 v[64:65], v[64:65], v[72:73]
    v_pk_add_f32 v[66:67], v[66:67], v[74:75]
    v_pk_add_f32 v[68:69], v[68:69], v[76:77]
    v_pk_add_f32 v[70:71], v[70:71], v[78:79]
    s_waitcnt lgkmcnt(12)
    v_pk_add_f32 v[80:81], v[80:81], v[88:89]
    v_pk_add_f32 v[82:83], v[82:83], v[90:91]
    v_pk_add_f32 v[84:85], v[84:85], v[92:93]
    v_pk_add_f32 v[86:87], v[86:87], v[94:95]
    v_pk_add_f32 v[64:65], v[64:65], v[80:81]
    v_pk_add_f32 v[66:67], v[66:67], v[82:83]
    v_pk_add_f32 v[68:69], v[68:69], v[84:85]
    v_pk_add_f32 v[70:71], v[70:71], v[86:87]
    v_cvt_pk_bf16_f32 v64, v64, v65
    v_cvt_pk_bf16_f32 v65, v66, v67
    v_cvt_pk_bf16_f32 v66, v68, v69
    v_cvt_pk_bf16_f32 v67, v70, v71
    buffer_store_dwordx4 v[64:67], v62, s[32:35], s79 offen sc1
    s_add_u32 s79, s79, 28672
    s_waitcnt lgkmcnt(8)
    v_pk_add_f32 v[96:97], v[96:97], v[104:105]
    v_pk_add_f32 v[98:99], v[98:99], v[106:107]
    v_pk_add_f32 v[100:101], v[100:101], v[108:109]
    v_pk_add_f32 v[102:103], v[102:103], v[110:111]
    s_waitcnt lgkmcnt(4)
    v_pk_add_f32 v[112:113], v[112:113], v[120:121]
    v_pk_add_f32 v[114:115], v[114:115], v[122:123]
    v_pk_add_f32 v[116:117], v[116:117], v[124:125]
    v_pk_add_f32 v[118:119], v[118:119], v[126:127]
    v_pk_add_f32 v[96:97], v[96:97], v[112:113]
    v_pk_add_f32 v[98:99], v[98:99], v[114:115]
    v_pk_add_f32 v[100:101], v[100:101], v[116:117]
    v_pk_add_f32 v[102:103], v[102:103], v[118:119]
    v_cvt_pk_bf16_f32 v96, v96, v97
    v_cvt_pk_bf16_f32 v97, v98, v99
    v_cvt_pk_bf16_f32 v98, v100, v101
    v_cvt_pk_bf16_f32 v99, v102, v103
    buffer_store_dwordx4 v[96:99], v62, s[32:35], s79 offen sc1
    s_add_u32 s79, s79, 28672
    s_waitcnt lgkmcnt(0)
    v_pk_add_f32 v[224:225], v[224:225], v[228:229]
    v_pk_add_f32 v[226:227], v[226:227], v[230:231]
    v_pk_add_f32 v[232:233], v[232:233], v[236:237]
    v_pk_add_f32 v[234:235], v[234:235], v[238:239]
    v_pk_add_f32 v[224:225], v[224:225], v[232:233]
    v_pk_add_f32 v[226:227], v[226:227], v[234:235]
    v_cvt_pk_bf16_f32 v224, v224, v225
    v_cvt_pk_bf16_f32 v225, v226, v227
    buffer_store_dwordx2 v[224:225], v23, s[32:35], s79 offen sc1
    s_endpgm
L_slow_1:
    s_mov_b32 s55, 0
    global_load_dword v48, v55, s[36:37] sc1
L_chk_2:
    s_waitcnt vmcnt(0)
    v_cmp_ne_u32 vcc, 1, v48
    s_cbranch_vccz L_ok_3
    global_load_dword v48, v55, s[36:37] sc1
    s_add_u32 s55, s55, 1
    s_cmp_lt_u32 s55, 400000
    s_cbranch_scc1 L_chk_2
    s_branch L_ok_3
L_slow_4:
    s_mov_b32 s55, 0
    buffer_load_dword v9, v50, s[28:31], 0 offen sc1
    s_sleep 3
    buffer_load_dword v10, v50, s[28:31], 0 offen sc1
    s_sleep 3
    buffer_load_dword v11, v50, s[28:31], 0 offen sc1
L_chk_5:
    s_waitcnt vmcnt(2)
    v_cmp_ne_u32 vcc, 1, v9
    s_cbranch_vccz L_ok_6
    buffer_load_dword v9, v50, s[28:31], 0 offen sc1
    s_waitcnt vmcnt(2)
    v_cmp_ne_u32 vcc, 1, v10
    s_cbranch_vccz L_ok_6
    buffer_load_dword v10, v50, s[28:31], 0 offen sc1
    s_waitcnt vmcnt(2)
    v_cmp_ne_u32 vcc, 1, v11
    s_cbranch_vccz L_ok_6
    buffer_load_dword v11, v50, s[28:31], 0 offen sc1
    s_add_u32 s55, s55, 1
    s_cmp_lt_u32 s55, 400000
    s_cbranch_scc1 L_chk_5
    s_branch L_ok_6
L_reo:
    s_mov_b32 s55, 0
L_reo_l:
    buffer_load_dwordx4 v[64:67], v240, s[16:19], s73 offen sc1
    buffer_load_dwordx4 v[84:87], v240, s[16:19], s74 offen sc1
    buffer_load_dwordx4 v[104:107], v240, s[16:19], s75 offen sc1
    buffer_load_dwordx4 v[124:127], v240, s[16:19], s76 offen sc1
    buffer_load_dwordx4 v[68:71], v241, s[16:19], s73 offen sc1
    buffer_load_dwordx4 v[88:91], v241, s[16:19], s74 offen sc1
    buffer_load_dwordx4 v[108:111], v241, s[16:19], s75 offen sc1
    buffer_load_dwordx4 v[224:227], v241, s[16:19], s76 offen sc1
    buffer_load_dwordx4 v[72:75], v242, s[16:19], s73 offen sc1
    buffer_load_dwordx4 v[92:95], v242, s[16:19], s74 offen sc1
    buffer_load_dwordx4 v[112:115], v242, s[16:19], s75 offen sc1
    buffer_load_dwordx4 v[228:231], v242, s[16:19], s76 offen sc1
    buffer_load_dwordx4 v[76:79], v243, s[16:19], s73 offen sc1
    buffer_load_dwordx4 v[96:99], v243, s[16:19], s74 offen sc1
    buffer_load_dwordx4 v[116:119], v243, s[16:19], s75 offen sc1
    buffer_load_dwordx4 v[232:235], v243, s[16:19], s76 offen sc1
    buffer_load_dwordx4 v[80:83], v244, s[16:19], s73 offen sc1
    buffer_load_dwordx4 v[100:103], v244, s[16:19], s74 offen sc1
    buffer_load_dwordx4 v[120:123], v244, s[16:19], s75 offen sc1
    buffer_load_dwordx4 v[236:239], v244, s[16:19], s76 offen sc1
    s_add_u32 s55, s55, 1
    s_waitcnt vmcnt(0)
    v_max3_u32 v22, v64, v65, v66
    v_max3_u32 v22, v22, v67, v84
    v_max3_u32 v22, v22, v85, v86
    v_max3_u32 v22, v22, v87, v104
    v_max3_u32 v22, v22, v105, v106
    v_max3_u32 v22, v22, v107, v124
    v_max3_u32 v22, v22, v125, v126
    v_max3_u32 v22, v22, v127, v68
    v_max3_u32 v22, v22, v69, v70
    v_max3_u32 v22, v22, v71, v88
    v_max3_u32 v22, v22, v89, v90
    v_max3_u32 v22, v22, v91, v108
    v_max3_u32 v22, v22, v109, v110
    v_max3_u32 v22, v22, v111, v224
    v_max3_u32 v22, v22, v225, v226
    v_max3_u32 v22, v22, v227, v72
    v_max3_u32 v22, v22, v73, v74
    v_max3_u32 v22, v22, v75, v92
    v_max3_u32 v22, v22, v93, v94
    v_max3_u32 v22, v22, v95, v112
    v_max3_u32 v22, v22, v113, v114
    v_max3_u32 v22, v22, v115, v228
    v_max3_u32 v22, v22, v229, v230
    v_max3_u32 v22, v22, v231, v76
    v_max3_u32 v22, v22, v77, v78
    v_max3_u32 v22, v22, v79, v96
    v_max3_u32 v22, v22, v97, v98
    v_max3_u32 v22, v22, v99, v116
    v_max3_u32 v22, v22, v117, v118
    v_max3_u32 v22, v22, v119, v232
    v_max3_u32 v22, v22, v233, v234
    v_max3_u32 v22, v22, v235, v80
    v_max3_u32 v22, v22, v81, v82
    v_max3_u32 v22, v22, v83, v100
    v_max3_u32 v22, v22, v101, v102
    v_max3_u32 v22, v22, v103, v120
    v_max3_u32 v22, v22, v121, v122
    v_max3_u32 v22, v22, v123, v236
    v_max3_u32 v22, v22, v237, v238
    v_max3_u32 v22, v22, v239, v239
    v_cmp_eq_u32 vcc, -1, v22
    s_cmp_lt_u32 s55, 400000
    s_cselect_b64 s[48:49], -1, 0
    s_and_b64 vcc, vcc, s[48:49]
    s_cbranch_vccnz L_reo_l
    s_setpc_b64 s[0:1]
L_rem:
    s_mov_b32 s55, 0
L_rem_l:
    buffer_load_dwordx3 v[56:58], v59, s[28:31], 0 offen sc1
    buffer_load_dwordx2 v[60:61], v252, s[28:31], 0 offen sc1
    s_add_u32 s55, s55, 1
    s_waitcnt vmcnt(0)
    v_max3_u32 v22, v56, v57, v58
    v_max3_u32 v22, v22, v60, v61
    v_cmp_eq_u32 vcc, -1, v22
    s_cmp_lt_u32 s55, 400000
    s_cselect_b64 s[48:49], -1, 0
    s_and_b64 vcc, vcc, s[48:49]
    s_cbranch_vccnz L_rem_l
    s_setpc_b64 s[0:1]
L_rex:
    s_mov_b32 s55, 0
L_rex_l:
    buffer_load_dwordx4 v[208:211], v47, s[28:31], s54 offen offset:0 sc1
    buffer_load_dwordx4 v[212:215], v47, s[28:31], s54 offen offset:1024 sc1
    buffer_load_dwordx2 v[216:217], v247, s[28:31], s54 offen offset:2048 sc1
    s_add_u32 s55, s55, 1
    s_waitcnt vmcnt(0)
    v_max3_u32 v22, v208, v209, v210
    v_max3_u32 v22, v22, v211, v212
    v_max3_u32 v22, v22, v213, v214
    v_max3_u32 v22, v22, v215, v216
    v_max3_u32 v22, v22, v217, v217
    v_cmp_eq_u32 vcc, -1, v22
    s_cmp_lt_u32 s55, 400000
    s_cselect_b64 s[48:49], -1, 0
    s_and_b64 vcc, vcc, s[48:49]
    s_cbranch_vccnz L_rex_l
    s_setpc_b64 s[0:1]
L_slow_7:
    s_mov_b32 s55, 0
    buffer_load_dword v12, v51, s[28:31], 0 offen sc1
    s_sleep 3
    buffer_load_dword v13, v51, s[28:31], 0 offen sc1
    s_sleep 3
    buffer_load_dword v253, v51, s[28:31], 0 offen sc1
L_chk_8:
    s_waitcnt vmcnt(2)
    v_cmp_ne_u32 vcc, 1, v12
    s_cbranch_vccz L_ok_9
    buffer_load_dword v12, v51, s[28:31], 0 offen sc1
    s_waitcnt vmcnt(2)
    v_cmp_ne_u32 vcc, 1, v13
    s_cbranch_vccz L_ok_9
    buffer_load_dword v13, v51, s[28:31], 0 offen sc1
    s_waitcnt vmcnt(2)
    v_cmp_ne_u32 vcc, 1, v253
    s_cbranch_vccz L_ok_9
    buffer_load_dword v253, v51, s[28:31], 0 offen sc1
    s_add_u32 s55, s55, 1
    s_cmp_lt_u32 s55, 400000
    s_cbranch_scc1 L_chk_8
    s_branch L_ok_9
L_slow_10:
    s_mov_b32 s55, 0
    buffer_load_dword v53, v52, s[28:31], 0 offen sc1
    s_sleep 3
    buffer_load_dword v63, v52, s[28:31], 0 offen sc1
    s_sleep 3
    buffer_load_dword v254, v52, s[28:31], 0 offen sc1
L_chk_11:
    s_waitcnt vmcnt(2)
    v_cmp_ne_u32 vcc, 1, v53
    s_cbranch_vccz L_ok_12
    buffer_load_dword v53, v52, s[28:31], 0 offen sc1
    s_waitcnt vmcnt(2)
    v_cmp_ne_u32 vcc, 1, v63
    s_cbranch_vccz L_ok_12
    buffer_load_dword v63, v52, s[28:31], 0 offen sc1
    s_waitcnt vmcnt(2)
    v_cmp_ne_u32 vcc, 1, v254
    s_cbranch_vccz L_ok_12
    buffer_load_dword v254, v52, s[28:31], 0 offen sc1
    s_add_u32 s55, s55, 1
    s_cmp_lt_u32 s55, 400000
    s_cbranch_scc1 L_chk_11
    s_branch L_ok_12
L_slow_13:
    s_call_b64 s[0:1], L_rem
    s_branch L_ok_14
L_slow_15:
    s_call_b64 s[0:1], L_reo
    s_branch L_ok_16
L_slow_17:
    s_call_b64 s[0:1], L_reo
    s_branch L_ok_18
L_slow_19:
    s_call_b64 s[0:1], L_reo
    s_branch L_ok_20
L_slow_21:
    s_call_b64 s[0:1], L_reo
    s_branch L_ok_22
L_slow_23:
    s_call_b64 s[0:1], L_rex
    s_branch L_ok_24
L_slow_25:
    s_call_b64 s[0:1], L_reo
    s_branch L_ok_26
L_att_main:
    s_mov_b64 exec, -1
    v_add_u32 v6, 41984, v5
    v_add_u32 v30, 83968, v5
    v_add_u32 v31, 125952, v5
    s_bfe_u32 s61, s45, 0x30004
    s_add_u32 s61, s61, s3
    s_cmp_ge_u32 s61, 7
    s_cselect_b32 s51, 7, 0
    s_sub_u32 s61, s61, s51
    buffer_load_dwordx4 v6, s[16:19], s47 offen offset:1024 lds
    buffer_load_dwordx4 v30, s[16:19], s47 offen offset:2048 lds
    buffer_load_dwordx4 v31, s[16:19], s47 offen offset:3072 lds
    s_load_dwordx2 s[28:29], s[0:1], 80
    s_load_dwordx2 s[36:37], s[0:1], 72
    s_load_dwordx2 s[38:39], s[0:1], 56
    v_and_b32 v29, 31, v0
    v_lshrrev_b32 v27, 5, v0
    v_bfe_u32 v28, v0, 1, 3
    v_xor_b32 v28, v28, v27
    v_lshl_add_u32 v28, v28, 4, s52
    v_lshl_add_u32 v7, v29, 7, v28
    v_xor_b32 v8, 32, v7
    v_xor_b32 v9, 64, v7
    v_xor_b32 v10, 96, v7
    v_bfe_u32 v24, v0, 2, 2
    v_lshlrev_b32 v28, 12, v27
    v_lshl_add_u32 v28, v24, 7, v28
    v_add_u32 v28, 32768, v28
    v_and_b32 v24, 8, v0
    v_lshlrev_b32 v24, 3, v24
    v_and_b32 v29, 16, v0
    v_and_b32 v19, 3, v0
    v_lshlrev_b32 v19, 3, v19
    v_lshl_add_u32 v29, v29, 1, v19
    v_add_u32 v19, 8, v29
    v_and_or_b32 v19, v19, 64, v29
    v_xad_u32 v15, v19, v24, v28
    v_add_u32 v29, 56, v29
    v_xad_u32 v16, v29, v24, v28
    v_mov_b32 v43, 0x358637bd
    v_mov_b32 v176, 0
    v_writelane_b32 v176, 1.0, 28
    v_writelane_b32 v176, 1.0, 60
    v_mov_b32 v192, v43
    v_mov_b32 v193, v43
    v_mov_b32 v194, v43
    v_mov_b32 v195, v43
    v_mov_b32 v196, v43
    v_mov_b32 v197, v43
    v_mov_b32 v198, v43
    v_mov_b32 v199, v43
    v_mov_b32 v200, v43
    v_mov_b32 v201, v43
    v_mov_b32 v202, v43
    v_mov_b32 v203, v43
    v_mov_b32 v204, v43
    v_mov_b32 v205, v43
    v_mov_b32 v206, v43
    v_mov_b32 v207, v43
    v_mov_b32 v177, v176
    v_mov_b32 v178, v176
    v_mov_b32 v179, v176
    v_mov_b32 v180, v176
    v_mov_b32 v181, v176
    v_mov_b32 v182, v176
    v_mov_b32 v183, v176
    v_mov_b32 v184, v176
    v_mov_b32 v185, v176
    v_mov_b32 v186, v176
    v_mov_b32 v187, v176
    v_mov_b32 v188, v176
    v_mov_b32 v189, v176
    v_mov_b32 v190, v176
    v_mov_b32 v191, v176
    s_add_u32 m0, s52, 49152
    s_lshl_b32 s46, s61, 7
    buffer_load_dwordx4 v1, s[4:7], s46 offen offset:0 lds
    buffer_load_dwordx4 v2, s[4:7], s46 offen offset:1024 lds
    buffer_load_dwordx4 v3, s[4:7], s46 offen offset:2048 lds
    buffer_load_dwordx4 v4, s[4:7], s46 offen offset:3072 lds
    s_add_u32 m0, s52, 53248
    s_add_u32 s56, s46, 28672
    buffer_load_dwordx4 v1, s[4:7], s56 offen offset:0 lds
    buffer_load_dwordx4 v2, s[4:7], s56 offen offset:1024 lds
    s_waitcnt vmcnt(9)
    s_waitcnt lgkmcnt(0)
    s_barrier
    ds_read_b128 a[0:3], v7 offset:0
    ds_read_b64_tr_b16 a[224:225], v15 offset:0
    ds_read_b64_tr_b16 a[226:227], v15 offset:512
    ds_read_b128 a[4:7], v7 offset:4096
    ds_read_b64_tr_b16 a[228:229], v16 offset:0
    ds_read_b64_tr_b16 a[230:231], v16 offset:512
    ds_read_b64_tr_b16 a[232:233], v15 offset:8192
    ds_read_b64_tr_b16 a[234:235], v15 offset:8704
    ds_read_b64_tr_b16 a[236:237], v16 offset:8192
    ds_read_b64_tr_b16 a[238:239], v16 offset:8704
    s_waitcnt vmcnt(8) lgkmcnt(4)
    s_barrier
    v_mfma_f32_32x32x16_bf16 v[64:79], a[0:3], a[224:227], v[192:207]
    ds_read_b128 a[8:11], v8 offset:0
    ds_read_b64_tr_b16 a[240:241], v15 offset:1024
    s_bfe_u32 s62, s45, 0x30008
    s_add_u32 s62, s62, s3
    s_cmp_ge_u32 s62, 7
    s_cselect_b32 s51, 7, 0
    v_mfma_f32_32x32x16_bf16 v[80:95], a[4:7], a[224:227], v[192:207]
    ds_read_b64_tr_b16 a[242:243], v15 offset:1536
    ds_read_b128 a[12:15], v8 offset:4096
    s_sub_u32 s62, s62, s51
    s_bfe_u32 s63, s45, 0x3000c
    s_add_u32 s63, s63, s3
    v_mfma_f32_32x32x16_bf16 v[96:111], a[0:3], a[228:231], v[192:207]
    ds_read_b64_tr_b16 a[244:245], v16 offset:1024
    ds_read_b64_tr_b16 a[246:247], v16 offset:1536
    buffer_load_dwordx4 v3, s[4:7], s56 offen offset:2048 lds
    s_cmp_ge_u32 s63, 7
    s_cselect_b32 s51, 7, 0
    v_mfma_f32_32x32x16_bf16 v[112:127], a[4:7], a[228:231], v[192:207]
    s_sub_u32 s63, s63, s51
    s_bfe_u32 s64, s45, 0x30010
    s_add_u32 s64, s64, s3
    s_cmp_ge_u32 s64, 7
    s_cselect_b32 s51, 7, 0
    s_waitcnt lgkmcnt(6)
    v_mfma_f32_32x32x16_bf16 v[128:143], a[0:3], a[232:235], v[176:191]
    ds_read_b64_tr_b16 a[248:249], v15 offset:9216
    ds_read_b64_tr_b16 a[250:251], v15 offset:9728
    buffer_load_dwordx4 v4, s[4:7], s56 offen offset:3072 lds
    s_sub_u32 s64, s64, s51
    s_bfe_u32 s65, s45, 0x30014
    v_mfma_f32_32x32x16_bf16 v[144:159], a[4:7], a[232:235], v[176:191]
    ds_read_b64_tr_b16 a[252:253], v16 offset:9216
    ds_read_b64_tr_b16 a[254:255], v16 offset:9728
    s_mul_i32 s47, s61, 172032
    s_add_u32 m0, s53, 81920
    s_add_u32 s65, s65, s3
    v_mfma_f32_32x32x16_bf16 v[160:175], a[0:3], a[236:239], v[176:191]
    s_add_u32 s47, s47, s57
    s_cmp_ge_u32 s65, 7
    s_cselect_b32 s51, 7, 0
    s_sub_u32 s65, s65, s51
    s_bfe_u32 s66, s45, 0x30018
    s_add_u32 s66, s66, s3
    v_mfma_f32_32x32x16_bf16 v[176:191], a[4:7], a[236:239], v[176:191]
    buffer_load_dwordx4 v5, s[16:19], s47 offen offset:0 lds
    s_cmp_ge_u32 s66, 7
    s_cselect_b32 s51, 7, 0
    s_sub_u32 s66, s66, s51
    s_waitcnt vmcnt(10) lgkmcnt(4)
    s_barrier
    v_mfma_f32_32x32x16_bf16 v[64:79], a[8:11], a[240:243], v[64:79]
    ds_read_b128 a[16:19], v9 offset:0
    ds_read_b64_tr_b16 a[224:225], v15 offset:2048
    v_add_u32 v11, 98304, v7
    v_add_u32 v12, 98304, v8
    v_add_u32 v13, 98304, v9
    v_add_u32 v14, 98304, v10
    v_mfma_f32_32x32x16_bf16 v[80:95], a[12:15], a[240:243], v[80:95]
    ds_read_b64_tr_b16 a[226:227], v15 offset:2560
    ds_read_b128 a[20:23], v9 offset:4096
    buffer_load_dwordx4 v6, s[16:19], s47 offen offset:1024 lds
    v_add_u32 v17, 65536, v15
    v_add_u32 v18, 65536, v16
    v_mfma_f32_32x32x16_bf16 v[96:111], a[8:11], a[244:247], v[96:111]
    ds_read_b64_tr_b16 a[228:229], v16 offset:2048
    ds_read_b64_tr_b16 a[230:231], v16 offset:2560
    s_and_b32 s49, s40, 1
    s_lshr_b32 s50, s40, 1
    s_mul_i32 s3, s50, 86016
    s_lshl1_add_u32 s54, s49, s50
    v_mfma_f32_32x32x16_bf16 v[112:127], a[12:15], a[244:247], v[112:127]
    buffer_load_dwordx4 v30, s[16:19], s47 offen offset:2048 lds
    s_lshl_b32 s54, s54, 11
    s_mov_b32 s30, 20971520
    s_mov_b32 s31, 0x20000
    s_waitcnt lgkmcnt(6)
    v_mfma_f32_32x32x16_bf16 v[128:143], a[8:11], a[248:251], v[128:143]
    ds_read_b64_tr_b16 a[232:233], v15 offset:10240
    ds_read_b64_tr_b16 a[234:235], v15 offset:10752
    s_mov_b32 s48, s66
    s_lshl4_add_u32 s48, s48, s65
    s_lshl4_add_u32 s48, s48, s64
    s_lshl4_add_u32 s48, s48, s63
    v_mfma_f32_32x32x16_bf16 v[144:159], a[12:15], a[248:251], v[144:159]
    ds_read_b64_tr_b16 a[236:237], v16 offset:10240
    ds_read_b64_tr_b16 a[238:239], v16 offset:10752
    buffer_load_dwordx4 v31, s[16:19], s47 offen offset:3072 lds
    s_lshl4_add_u32 s48, s48, s62
    s_lshl4_add_u32 s48, s48, s61
    v_mfma_f32_32x32x16_bf16 v[160:175], a[8:11], a[252:255], v[160:175]
    s_add_u32 m0, s52, 98304
    s_lshl_b32 s46, s62, 7
    s_lshl4_add_u32 s48, s48, s60
    v_lshlrev_b32 v28, 2, v25
    v_lshrrev_b32 v28, v28, s48
    v_and_b32 v36, 7, v28
    v_mfma_f32_32x32x16_bf16 v[176:191], a[12:15], a[252:255], v[176:191]
    buffer_load_dwordx4 v1, s[4:7], s46 offen offset:0 lds
    v_bfe_u32 v37, v28, 16, 3
    s_lshl2_add_u32 s48, s50, s49
    s_lshl_b32 s48, s48, 4
    s_waitcnt vmcnt(13) lgkmcnt(4)
    s_barrier
    v_mfma_f32_32x32x16_bf16 v[64:79], a[16:19], a[224:227], v[64:79]
    ds_read_b128 a[24:27], v10 offset:0
    ds_read_b64_tr_b16 a[240:241], v15 offset:3072
    v_and_b32 v28, 8, v0
    v_lshl_add_u32 v24, v28, 1, v26
    v_lshl_add_u32 v24, v24, 1, s48
    v_lshl_add_u32 v36, v36, 7, v24
    v_mfma_f32_32x32x16_bf16 v[80:95], a[20:23], a[224:227], v[80:95]
    ds_read_b64_tr_b16 a[242:243], v15 offset:3584
    ds_read_b128 a[28:31], v10 offset:4096
    v_lshl_add_u32 v37, v37, 7, v24
    v_mov_b32 v33, 0
    v_mov_b32 v35, 0
    v_and_b32 v24, 2, v0
    v_mfma_f32_32x32x16_bf16 v[96:111], a[16:19], a[228:231], v[96:111]
    ds_read_b64_tr_b16 a[244:245], v16 offset:3072
    ds_read_b64_tr_b16 a[246:247], v16 offset:3584
    buffer_load_dwordx4 v2, s[4:7], s46 offen offset:1024 lds
    v_lshlrev_b32 v24, 5, v24
    v_xor_b32 v24, 112, v24
    v_mfma_f32_32x32x16_bf16 v[112:127], a[20:23], a[228:231], v[112:127]
    v_and_b32 v29, 15, v0
    v_lshl_add_u32 v24, v29, 7, v24
    v_lshl_add_u32 v24, v25, 13, v24
    s_add_u32 s48, s54, 49152
    v_add_u32 v19, s48, v24
    s_waitcnt lgkmcnt(6)
    v_mfma_f32_32x32x16_bf16 v[128:143], a[16:19], a[232:235], v[128:143]
    ds_read_b64_tr_b16 a[248:249], v15 offset:11264
    ds_read_b64_tr_b16 a[250:251], v15 offset:11776
    buffer_load_dwordx4 v3, s[4:7], s46 offen offset:2048 lds
    v_lshlrev_b32 v23, 2, v0
    v_mov_b32 v21, 1
    v_mfma_f32_32x32x16_bf16 v[144:159], a[20:23], a[232:235], v[144:159]
    ds_read_b64_tr_b16 a[252:253], v16 offset:11264
    ds_read_b64_tr_b16 a[254:255], v16 offset:11776
    v_lshlrev_b32 v20, 2, v26
    v_lshlrev_b32 v40, 4, v0
    s_lshl_b32 s48, s42, 5
    s_add_u32 s49, s48, s40
    v_mfma_f32_32x32x16_bf16 v[160:175], a[16:19], a[236:239], v[160:175]
    buffer_load_dwordx4 v4, s[4:7], s46 offen offset:3072 lds
    s_add_u32 s48, s48, s44
    s_lshl_b32 s68, s48, 11
    s_add_u32 s68, s68, 11010048
    s_lshl_b32 s69, s49, 11
    v_mfma_f32_32x32x16_bf16 v[176:191], a[20:23], a[236:239], v[176:191]
    s_add_u32 m0, s52, 102400
    s_add_u32 s56, s46, 28672
    s_add_u32 s69, s69, 11010048
    s_lshl_b32 s67, s48, 7
    s_add_u32 s72, s67, 11819008
    s_waitcnt vmcnt(7) lgkmcnt(0)
    s_barrier
    v_mfma_f32_32x32x16_bf16 v[64:79], a[24:27], a[240:243], v[64:79]
    ds_read_b128 a[32:35], v7 offset:49152
    ds_read_b64_tr_b16 a[224:225], v15 offset:49152
    s_add_u32 s67, s67, 11786240
    s_lshl_b32 s49, s49, 7
    s_add_u32 s49, s49, 11786240
    v_lshl_add_u32 v38, v26, 9, s49
    v_mfma_f32_32x32x16_bf16 v[80:95], a[28:31], a[240:243], v[80:95]
    ds_read_b64_tr_b16 a[226:227], v15 offset:49664
    ds_read_b128 a[36:39], v7 offset:53248
    buffer_load_dwordx4 v1, s[4:7], s56 offen offset:0 lds
    s_mul_i32 s70, s44, 288
    s_lshl1_add_u32 s70, s42, s70
    v_mfma_f32_32x32x16_bf16 v[96:111], a[24:27], a[244:247], v[96:111]
    ds_read_b64_tr_b16 a[228:229], v16 offset:49152
    ds_read_b64_tr_b16 a[230:231], v16 offset:49664
    s_add_u32 s70, s70, 56
    s_lshl_b32 s70, s70, 10
    s_add_u32 s71, s70, 147456
    s_lshl_b32 s73, s42, 25
    v_mfma_f32_32x32x16_bf16 v[112:127], a[28:31], a[244:247], v[112:127]
    buffer_load_dwordx4 v2, s[4:7], s56 offen offset:1024 lds
    s_add_u32 s73, s73, 11534336
    v_and_b32 v24, 1, v25
    v_mul_u32_u24 v24, 73728, v24
    v_mfma_f32_32x32x16_bf16 v[128:143], a[24:27], a[248:251], v[128:143]
    ds_read_b64_tr_b16 a[232:233], v15 offset:57344
    ds_read_b64_tr_b16 a[234:235], v15 offset:57856
    v_lshl_add_u32 v29, v27, 4, v29
    v_lshl_add_u32 v41, v29, 4, v24
    v_add_u32 v60, s52, v40
    s_lshl_b32 s48, s40, 11
    v_mfma_f32_32x32x16_bf16 v[144:159], a[28:31], a[248:251], v[144:159]
    ds_read_b64_tr_b16 a[236:237], v16 offset:57344
    ds_read_b64_tr_b16 a[238:239], v16 offset:57856
    buffer_load_dwordx4 v3, s[4:7], s56 offen offset:2048 lds
    v_add_u32 v61, s48, v40
    v_add_u32 v63, 147456, v40
    v_mfma_f32_32x32x16_bf16 v[160:175], a[24:27], a[252:255], v[160:175]
    s_lshl_b32 s48, s40, 10
    v_add_u32 v62, s48, v63
    s_lshl_b32 s48, s44, 2
    v_add_u32 v24, s48, v25
    v_mul_u32_u24 v28, 205, v24
    v_lshrrev_b32 v28, 10, v28
    v_mfma_f32_32x32x16_bf16 v[176:191], a[28:31], a[252:255], v[176:191]
    buffer_load_dwordx4 v4, s[4:7], s56 offen offset:3072 lds
    v_mul_u32_u24 v28, 123, v28
    v_add_u32 v24, v24, v28
    v_and_b32 v28, 15, v0
    s_waitcnt vmcnt(10) lgkmcnt(4)
    s_barrier
    v_mfma_f32_32x32x16_bf16 v[64:79], a[32:35], a[224:227], v[64:79]
    ds_read_b128 a[40:43], v8 offset:49152
    ds_read_b64_tr_b16 a[240:241], v15 offset:50176
    s_mul_i32 s47, s62, 172032
    s_add_u32 m0, s53, 131072
    v_lshl_add_u32 v24, v28, 3, v24
    v_lshlrev_b32 v29, 2, v24
    v_mfma_f32_32x32x16_bf16 v[80:95], a[36:39], a[224:227], v[80:95]
    ds_read_b64_tr_b16 a[242:243], v15 offset:50688
    ds_read_b128 a[44:47], v8 offset:53248
    s_add_u32 s47, s47, s57
    v_mov_b32 v42, 0x3fb8aa3b
    v_mov_b32 v56, -1
    v_mov_b32 v57, -1
    v_mfma_f32_32x32x16_bf16 v[96:111], a[32:35], a[228:231], v[96:111]
    ds_read_b64_tr_b16 a[244:245], v16 offset:50176
    ds_read_b64_tr_b16 a[246:247], v16 offset:50688
    buffer_load_dwordx4 v5, s[16:19], s47 offen offset:0 lds
    v_mov_b32 v58, -1
    v_mov_b32 v59, -1
    v_mfma_f32_32x32x16_bf16 v[112:127], a[36:39], a[228:231], v[112:127]
    s_and_b32 s48, s40, 1
    s_sub_u32 s59, s48, 1
    s_mov_b32 s58, -1
    s_waitcnt lgkmcnt(6)
    v_mfma_f32_32x32x16_bf16 v[128:143], a[32:35], a[232:235], v[128:143]
    ds_read_b64_tr_b16 a[248:249], v15 offset:58368
    ds_read_b64_tr_b16 a[250:251], v15 offset:58880
    buffer_load_dwordx4 v6, s[16:19], s47 offen offset:1024 lds
    v_mfma_f32_32x32x16_bf16 v[144:159], a[36:39], a[232:235], v[144:159]
    ds_read_b64_tr_b16 a[252:253], v16 offset:58368
    ds_read_b64_tr_b16 a[254:255], v16 offset:58880
    v_mfma_f32_32x32x16_bf16 v[160:175], a[32:35], a[236:239], v[160:175]
    buffer_load_dwordx4 v30, s[16:19], s47 offen offset:2048 lds
    v_mfma_f32_32x32x16_bf16 v[176:191], a[36:39], a[236:239], v[176:191]
    s_waitcnt vmcnt(12) lgkmcnt(4)
    s_barrier
    v_mfma_f32_32x32x16_bf16 v[64:79], a[40:43], a[240:243], v[64:79]
    ds_read_b128 a[48:51], v9 offset:49152
    ds_read_b64_tr_b16 a[224:225], v15 offset:51200
    buffer_load_dwordx4 v31, s[16:19], s47 offen offset:3072 lds
    v_mfma_f32_32x32x16_bf16 v[80:95], a[44:47], a[240:243], v[80:95]
    ds_read_b64_tr_b16 a[226:227], v15 offset:51712
    ds_read_b128 a[52:55], v9 offset:53248
    s_add_u32 m0, s52, 0
    s_lshl_b32 s46, s63, 7
    v_mfma_f32_32x32x16_bf16 v[96:111], a[40:43], a[244:247], v[96:111]
    ds_read_b64_tr_b16 a[228:229], v16 offset:51200
    ds_read_b64_tr_b16 a[230:231], v16 offset:51712
    v_mfma_f32_32x32x16_bf16 v[112:127], a[44:47], a[244:247], v[112:127]
    buffer_load_dwordx4 v1, s[4:7], s46 offen offset:0 lds
    s_waitcnt lgkmcnt(6)
    v_mfma_f32_32x32x16_bf16 v[128:143], a[40:43], a[248:251], v[128:143]
    ds_read_b64_tr_b16 a[232:233], v15 offset:59392
    ds_read_b64_tr_b16 a[234:235], v15 offset:59904
    v_mfma_f32_32x32x16_bf16 v[144:159], a[44:47], a[248:251], v[144:159]
    ds_read_b64_tr_b16 a[236:237], v16 offset:59392
    ds_read_b64_tr_b16 a[238:239], v16 offset:59904
    buffer_load_dwordx4 v2, s[4:7], s46 offen offset:1024 lds
    v_mfma_f32_32x32x16_bf16 v[160:175], a[40:43], a[252:255], v[160:175]
    v_mfma_f32_32x32x16_bf16 v[176:191], a[44:47], a[252:255], v[176:191]
    buffer_load_dwordx4 v3, s[4:7], s46 offen offset:2048 lds
    s_waitcnt vmcnt(15) lgkmcnt(4)
    s_barrier
    v_mfma_f32_32x32x16_bf16 v[64:79], a[48:51], a[224:227], v[64:79]
    ds_read_b128 a[56:59], v10 offset:49152
    ds_read_b64_tr_b16 a[240:241], v15 offset:52224
    v_mfma_f32_32x32x16_bf16 v[80:95], a[52:55], a[224:227], v[80:95]
    ds_read_b64_tr_b16 a[242:243], v15 offset:52736
    ds_read_b128 a[60:63], v10 offset:53248
    v_mfma_f32_32x32x16_bf16 v[96:111], a[48:51], a[228:231], v[96:111]
    ds_read_b64_tr_b16 a[244:245], v16 offset:52224
    ds_read_b64_tr_b16 a[246:247], v16 offset:52736
    buffer_load_dwordx4 v4, s[4:7], s46 offen offset:3072 lds
    v_mfma_f32_32x32x16_bf16 v[112:127], a[52:55], a[228:231], v[112:127]
    s_add_u32 m0, s52, 4096
    s_add_u32 s56, s46, 28672
    s_waitcnt lgkmcnt(6)
    v_mfma_f32_32x32x16_bf16 v[128:143], a[48:51], a[232:235], v[128:143]
    ds_read_b64_tr_b16 a[248:249], v15 offset:60416
    ds_read_b64_tr_b16 a[250:251], v15 offset:60928
    buffer_load_dwordx4 v1, s[4:7], s56 offen offset:0 lds
    v_mfma_f32_32x32x16_bf16 v[144:159], a[52:55], a[232:235], v[144:159]
    ds_read_b64_tr_b16 a[252:253], v16 offset:60416
    ds_read_b64_tr_b16 a[254:255], v16 offset:60928
    v_mfma_f32_32x32x16_bf16 v[160:175], a[48:51], a[236:239], v[160:175]
    buffer_load_dwordx4 v2, s[4:7], s56 offen offset:1024 lds
    v_mfma_f32_32x32x16_bf16 v[176:191], a[52:55], a[236:239], v[176:191]
    s_waitcnt vmcnt(9) lgkmcnt(0)
    s_barrier
    v_mfma_f32_32x32x16_bf16 v[64:79], a[56:59], a[240:243], v[64:79]
    ds_read_b128 a[64:67], v11 offset:0
    ds_read_b64_tr_b16 a[224:225], v17 offset:32768
    buffer_load_dwordx4 v3, s[4:7], s56 offen offset:2048 lds
    v_mfma_f32_32x32x16_bf16 v[80:95], a[60:63], a[240:243], v[80:95]
    ds_read_b64_tr_b16 a[226:227], v17 offset:33280
    ds_read_b128 a[68:71], v11 offset:4096
    v_mfma_f32_32x32x16_bf16 v[96:111], a[56:59], a[244:247], v[96:111]
    ds_read_b64_tr_b16 a[228:229], v18 offset:32768
    ds_read_b64_tr_b16 a[230:231], v18 offset:33280
    v_mfma_f32_32x32x16_bf16 v[112:127], a[60:63], a[244:247], v[112:127]
    buffer_load_dwordx4 v4, s[4:7], s56 offen offset:3072 lds
    v_mfma_f32_32x32x16_bf16 v[128:143], a[56:59], a[248:251], v[128:143]
    ds_read_b64_tr_b16 a[232:233], v17 offset:40960
    ds_read_b64_tr_b16 a[234:235], v17 offset:41472
    s_mul_i32 s47, s63, 172032
    s_add_u32 m0, s53, 32768
    v_mfma_f32_32x32x16_bf16 v[144:159], a[60:63], a[248:251], v[144:159]
    ds_read_b64_tr_b16 a[236:237], v18 offset:40960
    ds_read_b64_tr_b16 a[238:239], v18 offset:41472
    s_add_u32 s47, s47, s57
    v_mfma_f32_32x32x16_bf16 v[160:175], a[56:59], a[252:255], v[160:175]
    buffer_load_dwordx4 v5, s[16:19], s47 offen offset:0 lds
    v_mfma_f32_32x32x16_bf16 v[176:191], a[60:63], a[252:255], v[176:191]
    s_waitcnt vmcnt(11) lgkmcnt(4)
    s_barrier
    v_mfma_f32_32x32x16_bf16 v[64:79], a[64:67], a[224:227], v[64:79]
    ds_read_b128 a[72:75], v12 offset:0
    ds_read_b64_tr_b16 a[240:241], v17 offset:33792
    buffer_load_dwordx4 v6, s[16:19], s47 offen offset:1024 lds
    v_mfma_f32_32x32x16_bf16 v[80:95], a[68:71], a[224:227], v[80:95]
    ds_read_b64_tr_b16 a[242:243], v17 offset:34304
    ds_read_b128 a[76:79], v12 offset:4096
    v_mfma_f32_32x32x16_bf16 v[96:111], a[64:67], a[228:231], v[96:111]
    ds_read_b64_tr_b16 a[244:245], v18 offset:33792
    ds_read_b64_tr_b16 a[246:247], v18 offset:34304
    buffer_load_dwordx4 v30, s[16:19], s47 offen offset:2048 lds
    v_mfma_f32_32x32x16_bf16 v[112:127], a[68:71], a[228:231], v[112:127]
    s_waitcnt lgkmcnt(6)
    v_mfma_f32_32x32x16_bf16 v[128:143], a[64:67], a[232:235], v[128:143]
    ds_read_b64_tr_b16 a[248:249], v17 offset:41984
    ds_read_b64_tr_b16 a[250:251], v17 offset:42496
    buffer_load_dwordx4 v31, s[16:19], s47 offen offset:3072 lds
    v_mfma_f32_32x32x16_bf16 v[144:159], a[68:71], a[232:235], v[144:159]
    ds_read_b64_tr_b16 a[252:253], v18 offset:41984
    ds_read_b64_tr_b16 a[254:255], v18 offset:42496
    s_add_u32 m0, s52, 49152
    s_lshl_b32 s46, s64, 7
    v_mfma_f32_32x32x16_bf16 v[160:175], a[64:67], a[236:239], v[160:175]
    buffer_load_dwordx4 v1, s[4:7], s46 offen offset:0 lds
    v_mfma_f32_32x32x16_bf16 v[176:191], a[68:71], a[236:239], v[176:191]
    s_waitcnt vmcnt(14) lgkmcnt(4)
    s_barrier
    v_mfma_f32_32x32x16_bf16 v[64:79], a[72:75], a[240:243], v[64:79]
    ds_read_b128 a[80:83], v13 offset:0
    ds_read_b64_tr_b16 a[224:225], v17 offset:34816
    v_mfma_f32_32x32x16_bf16 v[80:95], a[76:79], a[240:243], v[80:95]
    ds_read_b64_tr_b16 a[226:227], v17 offset:35328
    ds_read_b128 a[84:87], v13 offset:4096
    buffer_load_dwordx4 v2, s[4:7], s46 offen offset:1024 lds
    v_mfma_f32_32x32x16_bf16 v[96:111], a[72:75], a[244:247], v[96:111]
    ds_read_b64_tr_b16 a[228:229], v18 offset:34816
    ds_read_b64_tr_b16 a[230:231], v18 offset:35328
    v_mfma_f32_32x32x16_bf16 v[112:127], a[76:79], a[244:247], v[112:127]
    buffer_load_dwordx4 v3, s[4:7], s46 offen offset:2048 lds
    s_waitcnt lgkmcnt(6)
    v_mfma_f32_32x32x16_bf16 v[128:143], a[72:75], a[248:251], v[128:143]
    ds_read_b64_tr_b16 a[232:233], v17 offset:43008
    ds_read_b64_tr_b16 a[234:235], v17 offset:43520
    v_mfma_f32_32x32x16_bf16 v[144:159], a[76:79], a[248:251], v[144:159]
    ds_read_b64_tr_b16 a[236:237], v18 offset:43008
    ds_read_b64_tr_b16 a[238:239], v18 offset:43520
    buffer_load_dwordx4 v4, s[4:7], s46 offen offset:3072 lds
    v_mfma_f32_32x32x16_bf16 v[160:175], a[72:75], a[252:255], v[160:175]
    s_add_u32 m0, s52, 53248
    s_add_u32 s56, s46, 28672
    v_mfma_f32_32x32x16_bf16 v[176:191], a[76:79], a[252:255], v[176:191]
    s_waitcnt vmcnt(16) lgkmcnt(4)
    s_barrier
    v_mfma_f32_32x32x16_bf16 v[64:79], a[80:83], a[224:227], v[64:79]
    ds_read_b128 a[88:91], v14 offset:0
    ds_read_b64_tr_b16 a[240:241], v17 offset:35840
    buffer_load_dwordx4 v1, s[4:7], s56 offen offset:0 lds
    v_mfma_f32_32x32x16_bf16 v[80:95], a[84:87], a[224:227], v[80:95]
    ds_read_b64_tr_b16 a[242:243], v17 offset:36352
    ds_read_b128 a[92:95], v14 offset:4096
    v_mfma_f32_32x32x16_bf16 v[96:111], a[80:83], a[228:231], v[96:111]
    ds_read_b64_tr_b16 a[244:245], v18 offset:35840
    ds_read_b64_tr_b16 a[246:247], v18 offset:36352
    buffer_load_dwordx4 v2, s[4:7], s56 offen offset:1024 lds
    v_mfma_f32_32x32x16_bf16 v[112:127], a[84:87], a[228:231], v[112:127]
    s_waitcnt lgkmcnt(6)
    v_mfma_f32_32x32x16_bf16 v[128:143], a[80:83], a[232:235], v[128:143]
    ds_read_b64_tr_b16 a[248:249], v17 offset:44032
    ds_read_b64_tr_b16 a[250:251], v17 offset:44544
    buffer_load_dwordx4 v3, s[4:7], s56 offen offset:2048 lds
    v_mfma_f32_32x32x16_bf16 v[144:159], a[84:87], a[232:235], v[144:159]
    ds_read_b64_tr_b16 a[252:253], v18 offset:44032
    ds_read_b64_tr_b16 a[254:255], v18 offset:44544
    v_mfma_f32_32x32x16_bf16 v[160:175], a[80:83], a[236:239], v[160:175]
    buffer_load_dwordx4 v4, s[4:7], s56 offen offset:3072 lds
    v_mfma_f32_32x32x16_bf16 v[176:191], a[84:87], a[236:239], v[176:191]
    s_mul_i32 s47, s64, 172032
    s_add_u32 m0, s53, 81920
    s_waitcnt vmcnt(11) lgkmcnt(0)
    s_barrier
    v_mfma_f32_32x32x16_bf16 v[64:79], a[88:91], a[240:243], v[64:79]
    ds_read_b128 a[96:99], v7 offset:0
    ds_read_b64_tr_b16 a[224:225], v15 offset:0
    s_add_u32 s47, s47, s57
    v_mfma_f32_32x32x16_bf16 v[80:95], a[92:95], a[240:243], v[80:95]
    ds_read_b64_tr_b16 a[226:227], v15 offset:512
    ds_read_b128 a[100:103], v7 offset:4096
    buffer_load_dwordx4 v5, s[16:19], s47 offen offset:0 lds
    v_mfma_f32_32x32x16_bf16 v[96:111], a[88:91], a[244:247], v[96:111]
    ds_read_b64_tr_b16 a[228:229], v16 offset:0
    ds_read_b64_tr_b16 a[230:231], v16 offset:512
    v_mfma_f32_32x32x16_bf16 v[112:127], a[92:95], a[244:247], v[112:127]
    buffer_load_dwordx4 v6, s[16:19], s47 offen offset:1024 lds
    v_mfma_f32_32x32x16_bf16 v[128:143], a[88:91], a[248:251], v[128:143]
    ds_read_b64_tr_b16 a[232:233], v15 offset:8192
    ds_read_b64_tr_b16 a[234:235], v15 offset:8704
    v_mfma_f32_32x32x16_bf16 v[144:159], a[92:95], a[248:251], v[144:159]
    ds_read_b64_tr_b16 a[236:237], v16 offset:8192
    ds_read_b64_tr_b16 a[238:239], v16 offset:8704
    buffer_load_dwordx4 v30, s[16:19], s47 offen offset:2048 lds
    v_mfma_f32_32x32x16_bf16 v[160:175], a[88:91], a[252:255], v[160:175]
    v_mfma_f32_32x32x16_bf16 v[176:191], a[92:95], a[252:255], v[176:191]
    buffer_load_dwordx4 v31, s[16:19], s47 offen offset:3072 lds
    s_waitcnt vmcnt(14) lgkmcnt(4)
    s_barrier
    v_mfma_f32_32x32x16_bf16 v[64:79], a[96:99], a[224:227], v[64:79]
    ds_read_b128 a[104:107], v8 offset:0
    ds_read_b64_tr_b16 a[240:241], v15 offset:1024
    s_add_u32 m0, s52, 98304
    s_lshl_b32 s46, s65, 7
L_pad_att_0:
    s_cbranch_execz L_att_main
    v_mfma_f32_32x32x16_bf16 v[80:95], a[100:103], a[224:227], v[80:95]
    ds_read_b64_tr_b16 a[242:243], v15 offset:1536
    ds_read_b128 a[108:111], v8 offset:4096
    v_mfma_f32_32x32x16_bf16 v[96:111], a[96:99], a[228:231], v[96:111]
    ds_read_b64_tr_b16 a[244:245], v16 offset:1024
    ds_read_b64_tr_b16 a[246:247], v16 offset:1536
    buffer_load_dwordx4 v1, s[4:7], s46 offen offset:0 lds
    v_mfma_f32_32x32x16_bf16 v[112:127], a[100:103], a[228:231], v[112:127]
    s_waitcnt lgkmcnt(6)
    v_mfma_f32_32x32x16_bf16 v[128:143], a[96:99], a[232:235], v[128:143]
    ds_read_b64_tr_b16 a[248:249], v15 offset:9216
    ds_read_b64_tr_b16 a[250:251], v15 offset:9728
    buffer_load_dwordx4 v2, s[4:7], s46 offen offset:1024 lds
    v_mfma_f32_32x32x16_bf16 v[144:159], a[100:103], a[232:235], v[144:159]
    ds_read_b64_tr_b16 a[252:253], v16 offset:9216
    ds_read_b64_tr_b16 a[254:255], v16 offset:9728
    v_mfma_f32_32x32x16_bf16 v[160:175], a[96:99], a[236:239], v[160:175]
    buffer_load_dwordx4 v3, s[4:7], s46 offen offset:2048 lds
    v_mfma_f32_32x32x16_bf16 v[176:191], a[100:103], a[236:239], v[176:191]
    s_waitcnt vmcnt(16) lgkmcnt(4)
    s_barrier
    v_mfma_f32_32x32x16_bf16 v[64:79], a[104:107], a[240:243], v[64:79]
    ds_read_b128 a[112:115], v9 offset:0
    ds_read_b64_tr_b16 a[224:225], v15 offset:2048
    v_mfma_f32_32x32x16_bf16 v[80:95], a[108:111], a[240:243], v[80:95]
    ds_read_b64_tr_b16 a[226:227], v15 offset:2560
    ds_read_b128 a[116:119], v9 offset:4096
    buffer_load_dwordx4 v4, s[4:7], s46 offen offset:3072 lds
    v_mfma_f32_32x32x16_bf16 v[96:111], a[104:107], a[244:247], v[96:111]
    ds_read_b64_tr_b16 a[228:229], v16 offset:2048
    ds_read_b64_tr_b16 a[230:231], v16 offset:2560
    s_add_u32 m0, s52, 102400
    s_add_u32 s56, s46, 28672
    v_mfma_f32_32x32x16_bf16 v[112:127], a[108:111], a[244:247], v[112:127]
    buffer_load_dwordx4 v1, s[4:7], s56 offen offset:0 lds
    s_waitcnt lgkmcnt(6)
    v_mfma_f32_32x32x16_bf16 v[128:143], a[104:107], a[248:251], v[128:143]
    ds_read_b64_tr_b16 a[232:233], v15 offset:10240
    ds_read_b64_tr_b16 a[234:235], v15 offset:10752
    v_mfma_f32_32x32x16_bf16 v[144:159], a[108:111], a[248:251], v[144:159]
    ds_read_b64_tr_b16 a[236:237], v16 offset:10240
    ds_read_b64_tr_b16 a[238:239], v16 offset:10752
    buffer_load_dwordx4 v2, s[4:7], s56 offen offset:1024 lds
    v_mfma_f32_32x32x16_bf16 v[160:175], a[104:107], a[252:255], v[160:175]
    v_mfma_f32_32x32x16_bf16 v[176:191], a[108:111], a[252:255], v[176:191]
    buffer_load_dwordx4 v3, s[4:7], s56 offen offset:2048 lds
    s_waitcnt vmcnt(19) lgkmcnt(4)
    s_barrier
    v_mfma_f32_32x32x16_bf16 v[64:79], a[112:115], a[224:227], v[64:79]
    ds_read_b128 a[120:123], v10 offset:0
    ds_read_b64_tr_b16 a[240:241], v15 offset:3072
    v_mfma_f32_32x32x16_bf16 v[80:95], a[116:119], a[224:227], v[80:95]
    ds_read_b64_tr_b16 a[242:243], v15 offset:3584
    ds_read_b128 a[124:127], v10 offset:4096
    v_mfma_f32_32x32x16_bf16 v[96:111], a[112:115], a[228:231], v[96:111]
    ds_read_b64_tr_b16 a[244:245], v16 offset:3072
    ds_read_b64_tr_b16 a[246:247], v16 offset:3584
    buffer_load_dwordx4 v4, s[4:7], s56 offen offset:3072 lds
    v_mfma_f32_32x32x16_bf16 v[112:127], a[116:119], a[228:231], v[112:127]
    s_mul_i32 s47, s65, 172032
    s_add_u32 m0, s53, 131072
    s_waitcnt lgkmcnt(6)
    v_mfma_f32_32x32x16_bf16 v[128:143], a[112:115], a[232:235], v[128:143]
    ds_read_b64_tr_b16 a[248:249], v15 offset:11264
    ds_read_b64_tr_b16 a[250:251], v15 offset:11776
    s_add_u32 s47, s47, s57
    v_mfma_f32_32x32x16_bf16 v[144:159], a[116:119], a[232:235], v[144:159]
    ds_read_b64_tr_b16 a[252:253], v16 offset:11264
    ds_read_b64_tr_b16 a[254:255], v16 offset:11776
    buffer_load_dwordx4 v5, s[16:19], s47 offen offset:0 lds
    v_mfma_f32_32x32x16_bf16 v[160:175], a[112:115], a[236:239], v[160:175]
    v_mfma_f32_32x32x16_bf16 v[176:191], a[116:119], a[236:239], v[176:191]
    buffer_load_dwordx4 v6, s[16:19], s47 offen offset:1024 lds
    s_waitcnt vmcnt(10) lgkmcnt(0)
    s_barrier
    v_mfma_f32_32x32x16_bf16 v[64:79], a[120:123], a[240:243], v[64:79]
    ds_read_b128 a[128:131], v7 offset:49152
    ds_read_b64_tr_b16 a[224:225], v15 offset:49152
    v_mfma_f32_32x32x16_bf16 v[80:95], a[124:127], a[240:243], v[80:95]
    ds_read_b64_tr_b16 a[226:227], v15 offset:49664
    ds_read_b128 a[132:135], v7 offset:53248
    buffer_load_dwordx4 v30, s[16:19], s47 offen offset:2048 lds
    v_mfma_f32_32x32x16_bf16 v[96:111], a[120:123], a[244:247], v[96:111]
    ds_read_b64_tr_b16 a[228:229], v16 offset:49152
    ds_read_b64_tr_b16 a[230:231], v16 offset:49664
    v_mfma_f32_32x32x16_bf16 v[112:127], a[124:127], a[244:247], v[112:127]
    buffer_load_dwordx4 v31, s[16:19], s47 offen offset:3072 lds
    v_mfma_f32_32x32x16_bf16 v[128:143], a[120:123], a[248:251], v[128:143]
    ds_read_b64_tr_b16 a[232:233], v15 offset:57344
    ds_read_b64_tr_b16 a[234:235], v15 offset:57856
    v_mfma_f32_32x32x16_bf16 v[144:159], a[124:127], a[248:251], v[144:159]
    ds_read_b64_tr_b16 a[236:237], v16 offset:57344
    ds_read_b64_tr_b16 a[238:239], v16 offset:57856
    global_load_ushort v32, v36, s[38:39]
    v_mfma_f32_32x32x16_bf16 v[160:175], a[120:123], a[252:255], v[160:175]
    v_mfma_f32_32x32x16_bf16 v[176:191], a[124:127], a[252:255], v[176:191]
    s_waitcnt lgkmcnt(4)
    v_mfma_f32_32x32x16_bf16 v[64:79], a[128:131], a[224:227], v[64:79]
    ds_read_b128 a[136:139], v8 offset:49152
    ds_read_b64_tr_b16 a[240:241], v15 offset:50176
    global_load_ushort v34, v37, s[38:39]
    v_mfma_f32_32x32x16_bf16 v[80:95], a[132:135], a[224:227], v[80:95]
    ds_read_b64_tr_b16 a[242:243], v15 offset:50688
    ds_read_b128 a[140:143], v8 offset:53248
    v_mfma_f32_32x32x16_bf16 v[96:111], a[128:131], a[228:231], v[96:111]
    ds_read_b64_tr_b16 a[244:245], v16 offset:50176
    ds_read_b64_tr_b16 a[246:247], v16 offset:50688
    buffer_store_dwordx4 v[56:59], v40, s[28:31], s68 offen offset:0 sc1
    v_mfma_f32_32x32x16_bf16 v[112:127], a[132:135], a[228:231], v[112:127]
    s_add_u32 m0, s52, 0
    s_lshl_b32 s46, s66, 7
    s_waitcnt lgkmcnt(6)
    v_mfma_f32_32x32x16_bf16 v[128:143], a[128:131], a[232:235], v[128:143]
    ds_read_b64_tr_b16 a[248:249], v15 offset:58368
    ds_read_b64_tr_b16 a[250:251], v15 offset:58880
    buffer_load_dwordx4 v1, s[4:7], s46 offen offset:0 lds
    v_mfma_f32_32x32x16_bf16 v[144:159], a[132:135], a[232:235], v[144:159]
    ds_read_b64_tr_b16 a[252:253], v16 offset:58368
    ds_read_b64_tr_b16 a[254:255], v16 offset:58880
    v_mfma_f32_32x32x16_bf16 v[160:175], a[128:131], a[236:239], v[160:175]
    v_mfma_f32_32x32x16_bf16 v[176:191], a[132:135], a[236:239], v[176:191]
    buffer_load_dwordx4 v2, s[4:7], s46 offen offset:1024 lds
    s_waitcnt lgkmcnt(4)
    v_mfma_f32_32x32x16_bf16 v[64:79], a[136:139], a[240:243], v[64:79]
    ds_read_b128 a[144:147], v9 offset:49152
    ds_read_b64_tr_b16 a[224:225], v15 offset:51200
    v_mfma_f32_32x32x16_bf16 v[80:95], a[140:143], a[240:243], v[80:95]
    ds_read_b64_tr_b16 a[226:227], v15 offset:51712
    ds_read_b128 a[148:151], v9 offset:53248
    buffer_load_dwordx4 v3, s[4:7], s46 offen offset:2048 lds
    v_mfma_f32_32x32x16_bf16 v[96:111], a[136:139], a[244:247], v[96:111]
    ds_read_b64_tr_b16 a[228:229], v16 offset:51200
    ds_read_b64_tr_b16 a[230:231], v16 offset:51712
    v_mfma_f32_32x32x16_bf16 v[112:127], a[140:143], a[244:247], v[112:127]
    buffer_load_dwordx4 v4, s[4:7], s46 offen offset:3072 lds
    s_waitcnt lgkmcnt(6)
    v_mfma_f32_32x32x16_bf16 v[128:143], a[136:139], a[248:251], v[128:143]
    ds_read_b64_tr_b16 a[232:233], v15 offset:59392
    ds_read_b64_tr_b16 a[234:235], v15 offset:59904
    s_add_u32 m0, s52, 4096
    s_add_u32 s56, s46, 28672
    v_mfma_f32_32x32x16_bf16 v[144:159], a[140:143], a[248:251], v[144:159]
    ds_read_b64_tr_b16 a[236:237], v16 offset:59392
    ds_read_b64_tr_b16 a[238:239], v16 offset:59904
    buffer_load_dwordx4 v1, s[4:7], s56 offen offset:0 lds
    v_mfma_f32_32x32x16_bf16 v[160:175], a[136:139], a[252:255], v[160:175]
    v_mfma_f32_32x32x16_bf16 v[176:191], a[140:143], a[252:255], v[176:191]
    s_waitcnt lgkmcnt(4)
    v_mfma_f32_32x32x16_bf16 v[64:79], a[144:147], a[224:227], v[64:79]
    ds_read_b128 a[152:155], v10 offset:49152
    ds_read_b64_tr_b16 a[240:241], v15 offset:52224
    buffer_load_dwordx4 v2, s[4:7], s56 offen offset:1024 lds
    v_mfma_f32_32x32x16_bf16 v[80:95], a[148:151], a[224:227], v[80:95]
    ds_read_b64_tr_b16 a[242:243], v15 offset:52736
    ds_read_b128 a[156:159], v10 offset:53248
    v_mfma_f32_32x32x16_bf16 v[96:111], a[144:147], a[228:231], v[96:111]
    ds_read_b64_tr_b16 a[244:245], v16 offset:52224
    ds_read_b64_tr_b16 a[246:247], v16 offset:52736
    buffer_load_dwordx4 v3, s[4:7], s56 offen offset:2048 lds
    v_mfma_f32_32x32x16_bf16 v[112:127], a[148:151], a[228:231], v[112:127]
    s_waitcnt lgkmcnt(6)
    v_mfma_f32_32x32x16_bf16 v[128:143], a[144:147], a[232:235], v[128:143]
    ds_read_b64_tr_b16 a[248:249], v15 offset:60416
    ds_read_b64_tr_b16 a[250:251], v15 offset:60928
    buffer_load_dwordx4 v4, s[4:7], s56 offen offset:3072 lds
    v_mfma_f32_32x32x16_bf16 v[144:159], a[148:151], a[232:235], v[144:159]
    ds_read_b64_tr_b16 a[252:253], v16 offset:60416
    ds_read_b64_tr_b16 a[254:255], v16 offset:60928
    s_mul_i32 s47, s66, 172032
    s_add_u32 m0, s53, 32768
    v_mfma_f32_32x32x16_bf16 v[160:175], a[144:147], a[236:239], v[160:175]
    s_add_u32 s47, s47, s57
    v_mfma_f32_32x32x16_bf16 v[176:191], a[148:151], a[236:239], v[176:191]
    buffer_load_dwordx4 v5, s[16:19], s47 offen offset:0 lds
    s_waitcnt vmcnt(12) lgkmcnt(0)
    s_barrier
    v_mfma_f32_32x32x16_bf16 v[64:79], a[152:155], a[240:243], v[64:79]
    ds_read_b128 a[160:163], v11 offset:0
    ds_read_b64_tr_b16 a[224:225], v17 offset:32768
    v_mfma_f32_32x32x16_bf16 v[80:95], a[156:159], a[240:243], v[80:95]
    ds_read_b64_tr_b16 a[226:227], v17 offset:33280
    ds_read_b128 a[164:167], v11 offset:4096
    buffer_load_dwordx4 v6, s[16:19], s47 offen offset:1024 lds
    v_mfma_f32_32x32x16_bf16 v[96:111], a[152:155], a[244:247], v[96:111]
    ds_read_b64_tr_b16 a[228:229], v18 offset:32768
    ds_read_b64_tr_b16 a[230:231], v18 offset:33280
    v_mfma_f32_32x32x16_bf16 v[112:127], a[156:159], a[244:247], v[112:127]
    buffer_load_dwordx4 v30, s[16:19], s47 offen offset:2048 lds
    v_mfma_f32_32x32x16_bf16 v[128:143], a[152:155], a[248:251], v[128:143]
    ds_read_b64_tr_b16 a[232:233], v17 offset:40960
    ds_read_b64_tr_b16 a[234:235], v17 offset:41472
    v_mfma_f32_32x32x16_bf16 v[144:159], a[156:159], a[248:251], v[144:159]
    ds_read_b64_tr_b16 a[236:237], v18 offset:40960
    ds_read_b64_tr_b16 a[238:239], v18 offset:41472
    buffer_load_dwordx4 v31, s[16:19], s47 offen offset:3072 lds
    v_mfma_f32_32x32x16_bf16 v[160:175], a[152:155], a[252:255], v[160:175]
    v_mfma_f32_32x32x16_bf16 v[176:191], a[156:159], a[252:255], v[176:191]
    s_waitcnt lgkmcnt(4)
    v_mfma_f32_32x32x16_bf16 v[64:79], a[160:163], a[224:227], v[64:79]
    ds_read_b128 a[168:171], v12 offset:0
    ds_read_b64_tr_b16 a[240:241], v17 offset:33792
    global_load_dword v22, v20, s[36:37]
    v_mfma_f32_32x32x16_bf16 v[80:95], a[164:167], a[224:227], v[80:95]
    ds_read_b64_tr_b16 a[242:243], v17 offset:34304
    ds_read_b128 a[172:175], v12 offset:4096
    s_mul_i32 s47, s60, 172032
    s_add_u32 m0, s54, 49152
    v_mfma_f32_32x32x16_bf16 v[96:111], a[160:163], a[228:231], v[96:111]
    ds_read_b64_tr_b16 a[244:245], v18 offset:33792
    ds_read_b64_tr_b16 a[246:247], v18 offset:34304
    s_add_u32 s47, s47, s3
    v_mfma_f32_32x32x16_bf16 v[112:127], a[164:167], a[228:231], v[112:127]
    buffer_load_dwordx4 v5, s[16:19], s47 offen offset:0 lds
    s_waitcnt lgkmcnt(6)
    v_mfma_f32_32x32x16_bf16 v[128:143], a[160:163], a[232:235], v[128:143]
    ds_read_b64_tr_b16 a[248:249], v17 offset:41984
    ds_read_b64_tr_b16 a[250:251], v17 offset:42496
    v_mfma_f32_32x32x16_bf16 v[144:159], a[164:167], a[232:235], v[144:159]
    ds_read_b64_tr_b16 a[252:253], v18 offset:41984
    ds_read_b64_tr_b16 a[254:255], v18 offset:42496
    buffer_load_dwordx4 v6, s[16:19], s47 offen offset:1024 lds
    v_mfma_f32_32x32x16_bf16 v[160:175], a[160:163], a[236:239], v[160:175]
    s_mul_i32 s47, s61, 172032
    s_add_u32 m0, s54, 57344
    v_mfma_f32_32x32x16_bf16 v[176:191], a[164:167], a[236:239], v[176:191]
    s_add_u32 s47, s47, s3
    s_waitcnt lgkmcnt(4)
    v_mfma_f32_32x32x16_bf16 v[64:79], a[168:171], a[240:243], v[64:79]
    ds_read_b128 a[176:179], v13 offset:0
    ds_read_b64_tr_b16 a[224:225], v17 offset:34816
    buffer_load_dwordx4 v5, s[16:19], s47 offen offset:0 lds
    v_mfma_f32_32x32x16_bf16 v[80:95], a[172:175], a[240:243], v[80:95]
    ds_read_b64_tr_b16 a[226:227], v17 offset:35328
    ds_read_b128 a[180:183], v13 offset:4096
    v_mfma_f32_32x32x16_bf16 v[96:111], a[168:171], a[244:247], v[96:111]
    ds_read_b64_tr_b16 a[228:229], v18 offset:34816
    ds_read_b64_tr_b16 a[230:231], v18 offset:35328
    buffer_load_dwordx4 v6, s[16:19], s47 offen offset:1024 lds
    v_mfma_f32_32x32x16_bf16 v[112:127], a[172:175], a[244:247], v[112:127]
    s_mul_i32 s47, s62, 172032
    s_add_u32 m0, s54, 65536
    s_waitcnt lgkmcnt(6)
    v_mfma_f32_32x32x16_bf16 v[128:143], a[168:171], a[248:251], v[128:143]
    ds_read_b64_tr_b16 a[232:233], v17 offset:43008
    ds_read_b64_tr_b16 a[234:235], v17 offset:43520
    s_add_u32 s47, s47, s3
    v_mfma_f32_32x32x16_bf16 v[144:159], a[172:175], a[248:251], v[144:159]
    ds_read_b64_tr_b16 a[236:237], v18 offset:43008
    ds_read_b64_tr_b16 a[238:239], v18 offset:43520
    buffer_load_dwordx4 v5, s[16:19], s47 offen offset:0 lds
    v_mfma_f32_32x32x16_bf16 v[160:175], a[168:171], a[252:255], v[160:175]
    v_mfma_f32_32x32x16_bf16 v[176:191], a[172:175], a[252:255], v[176:191]
    buffer_load_dwordx4 v6, s[16:19], s47 offen offset:1024 lds
    s_waitcnt lgkmcnt(4)
    v_mfma_f32_32x32x16_bf16 v[64:79], a[176:179], a[224:227], v[64:79]
    ds_read_b128 a[184:187], v14 offset:0
    ds_read_b64_tr_b16 a[240:241], v17 offset:35840
    s_mul_i32 s47, s63, 172032
    s_add_u32 m0, s54, 73728
    v_mfma_f32_32x32x16_bf16 v[80:95], a[180:183], a[224:227], v[80:95]
    ds_read_b64_tr_b16 a[242:243], v17 offset:36352
    ds_read_b128 a[188:191], v14 offset:4096
    s_add_u32 s47, s47, s3
    v_mfma_f32_32x32x16_bf16 v[96:111], a[176:179], a[228:231], v[96:111]
    ds_read_b64_tr_b16 a[244:245], v18 offset:35840
    ds_read_b64_tr_b16 a[246:247], v18 offset:36352
    buffer_load_dwordx4 v5, s[16:19], s47 offen offset:0 lds
    v_mfma_f32_32x32x16_bf16 v[112:127], a[180:183], a[228:231], v[112:127]
    s_waitcnt lgkmcnt(6)
    v_mfma_f32_32x32x16_bf16 v[128:143], a[176:179], a[232:235], v[128:143]
    ds_read_b64_tr_b16 a[248:249], v17 offset:44032
    ds_read_b64_tr_b16 a[250:251], v17 offset:44544
    buffer_load_dwordx4 v6, s[16:19], s47 offen offset:1024 lds
    v_mfma_f32_32x32x16_bf16 v[144:159], a[180:183], a[232:235], v[144:159]
    ds_read_b64_tr_b16 a[252:253], v18 offset:44032
    ds_read_b64_tr_b16 a[254:255], v18 offset:44544
    v_mfma_f32_32x32x16_bf16 v[160:175], a[176:179], a[236:239], v[160:175]
    v_mfma_f32_32x32x16_bf16 v[176:191], a[180:183], a[236:239], v[176:191]
    s_waitcnt vmcnt(9) lgkmcnt(0)
    s_barrier
    s_waitcnt vmcnt(8)
    v_cmp_ne_u32 vcc, 1, v22
    s_cbranch_vccnz L_slow_27
L_ok_29:
    s_mov_b64 exec, 0xffff
    buffer_store_dword v21, v23, s[28:31], s67 offen sc1
    s_mov_b64 exec, -1
    v_mfma_f32_32x32x16_bf16 v[64:79], a[184:187], a[240:243], v[64:79]
    ds_read_b128 a[192:195], v7 offset:0
    ds_read_b64_tr_b16 a[224:225], v15 offset:0
    s_mul_i32 s47, s64, 172032
    s_add_u32 m0, s54, 98304
    v_mfma_f32_32x32x16_bf16 v[80:95], a[188:191], a[240:243], v[80:95]
    ds_read_b64_tr_b16 a[226:227], v15 offset:512
    ds_read_b128 a[196:199], v7 offset:4096
    s_add_u32 s47, s47, s3
    v_mfma_f32_32x32x16_bf16 v[96:111], a[184:187], a[244:247], v[96:111]
    ds_read_b128 a[200:203], v8 offset:0
    ds_read_b64_tr_b16 a[228:229], v15 offset:1024
    buffer_load_dwordx4 v5, s[16:19], s47 offen offset:0 lds
    v_mfma_f32_32x32x16_bf16 v[112:127], a[188:191], a[244:247], v[112:127]
    ds_read_b64_tr_b16 a[230:231], v15 offset:1536
    ds_read_b128 a[204:207], v8 offset:4096
    v_mfma_f32_32x32x16_bf16 v[128:143], a[184:187], a[248:251], v[128:143]
    ds_read_b128 a[208:211], v9 offset:0
    ds_read_b64_tr_b16 a[232:233], v15 offset:2048
    buffer_load_dwordx4 v6, s[16:19], s47 offen offset:1024 lds
    v_mfma_f32_32x32x16_bf16 v[144:159], a[188:191], a[248:251], v[144:159]
    ds_read_b64_tr_b16 a[234:235], v15 offset:2560
    ds_read_b128 a[212:215], v9 offset:4096
    s_mul_i32 s47, s65, 172032
    s_add_u32 m0, s54, 106496
    v_mfma_f32_32x32x16_bf16 v[160:175], a[184:187], a[252:255], v[160:175]
    ds_read_b128 a[216:219], v10 offset:0
    ds_read_b64_tr_b16 a[236:237], v15 offset:3072
    s_add_u32 s47, s47, s3
    v_mfma_f32_32x32x16_bf16 v[176:191], a[188:191], a[252:255], v[176:191]
    ds_read_b64_tr_b16 a[238:239], v15 offset:3584
    ds_read_b128 a[220:223], v10 offset:4096
    buffer_load_dwordx4 v5, s[16:19], s47 offen offset:0 lds
    s_waitcnt lgkmcnt(8)
    v_mfma_f32_32x32x16_bf16 v[64:79], a[192:195], a[224:227], v[64:79]
    ds_read_b64_tr_b16 a[240:241], v16 offset:0
    ds_read_b64_tr_b16 a[242:243], v16 offset:512
    v_mfma_f32_32x32x16_bf16 v[80:95], a[196:199], a[224:227], v[80:95]
    ds_read_b64_tr_b16 a[244:245], v16 offset:1024
    ds_read_b64_tr_b16 a[246:247], v16 offset:1536
    buffer_load_dwordx4 v6, s[16:19], s47 offen offset:1024 lds
    v_mfma_f32_32x32x16_bf16 v[64:79], a[200:203], a[228:231], v[64:79]
    s_mul_i32 s47, s66, 172032
    s_add_u32 m0, s54, 114688
    v_mfma_f32_32x32x16_bf16 v[80:95], a[204:207], a[228:231], v[80:95]
    s_add_u32 s47, s47, s3
    s_waitcnt lgkmcnt(4)
    v_mfma_f32_32x32x16_bf16 v[64:79], a[208:211], a[232:235], v[64:79]
    ds_read_b64_tr_b16 a[248:249], v16 offset:2048
    ds_read_b64_tr_b16 a[250:251], v16 offset:2560
    buffer_load_dwordx4 v5, s[16:19], s47 offen offset:0 lds
    v_mfma_f32_32x32x16_bf16 v[80:95], a[212:215], a[232:235], v[80:95]
    ds_read_b64_tr_b16 a[252:253], v16 offset:3072
    ds_read_b64_tr_b16 a[254:255], v16 offset:3584
    v_mfma_f32_32x32x16_bf16 v[64:79], a[216:219], a[236:239], v[64:79]
    buffer_load_dwordx4 v6, s[16:19], s47 offen offset:1024 lds
    v_mfma_f32_32x32x16_bf16 v[80:95], a[220:223], a[236:239], v[80:95]
    s_waitcnt lgkmcnt(4)
    v_mfma_f32_32x32x16_bf16 v[96:111], a[192:195], a[240:243], v[96:111]
    ds_read_b64_tr_b16 a[224:225], v15 offset:8192
    ds_read_b64_tr_b16 a[226:227], v15 offset:8704
    v_mfma_f32_32x32x16_bf16 v[112:127], a[196:199], a[240:243], v[112:127]
    ds_read_b64_tr_b16 a[228:229], v15 offset:9216
    ds_read_b64_tr_b16 a[230:231], v15 offset:9728
    v_mfma_f32_32x32x16_bf16 v[96:111], a[200:203], a[244:247], v[96:111]
    v_mfma_f32_32x32x16_bf16 v[112:127], a[204:207], a[244:247], v[112:127]
    s_waitcnt vmcnt(7)
    ds_write_b64 v19, v[32:33] offset:0
    s_waitcnt lgkmcnt(5)
    v_mfma_f32_32x32x16_bf16 v[96:111], a[208:211], a[248:251], v[96:111]
    ds_read_b64_tr_b16 a[232:233], v15 offset:10240
    ds_read_b64_tr_b16 a[234:235], v15 offset:10752
    v_fmaak_f32 v44, v64, v42, 0xb5c1a2a0
    v_fmaak_f32 v45, v65, v42, 0xb5c1a2a0
    v_fmaak_f32 v46, v66, v42, 0xb5c1a2a0
    v_fmaak_f32 v47, v67, v42, 0xb5c1a2a0
    v_mfma_f32_32x32x16_bf16 v[112:127], a[212:215], a[248:251], v[112:127]
    ds_read_b64_tr_b16 a[236:237], v15 offset:11264
    ds_read_b64_tr_b16 a[238:239], v15 offset:11776
    v_exp_f32_e64 v44, v44 clamp
    v_exp_f32_e64 v45, v45 clamp
    v_mfma_f32_32x32x16_bf16 v[96:111], a[216:219], a[252:255], v[96:111]
    v_exp_f32_e64 v46, v46 clamp
    v_exp_f32_e64 v47, v47 clamp
    v_max_f32 v64, v43, v64
    v_max_f32 v65, v43, v65
    v_mfma_f32_32x32x16_bf16 v[112:127], a[220:223], a[252:255], v[112:127]
    v_max_f32 v66, v43, v66
    v_max_f32 v67, v43, v67
    v_add_f32 v64, v64, v44
    v_add_f32 v65, v65, v45
    v_add_f32 v66, v66, v46
    s_waitcnt lgkmcnt(5)
    v_mfma_f32_32x32x16_bf16 v[128:143], a[192:195], a[224:227], v[128:143]
    ds_read_b64_tr_b16 a[240:241], v16 offset:8192
    ds_read_b64_tr_b16 a[242:243], v16 offset:8704
    v_add_f32 v67, v67, v47
    v_cvt_pk_bf16_f32 v64, v64, v65
    v_cvt_pk_bf16_f32 v65, v66, v67
    v_fmaak_f32 v44, v68, v42, 0xb5c1a2a0
    v_mfma_f32_32x32x16_bf16 v[144:159], a[196:199], a[224:227], v[144:159]
    ds_read_b64_tr_b16 a[244:245], v16 offset:9216
    ds_read_b64_tr_b16 a[246:247], v16 offset:9728
    v_fmaak_f32 v45, v69, v42, 0xb5c1a2a0
    v_fmaak_f32 v46, v70, v42, 0xb5c1a2a0
    v_fmaak_f32 v47, v71, v42, 0xb5c1a2a0
    v_mfma_f32_32x32x16_bf16 v[128:143], a[200:203], a[228:231], v[128:143]
    v_exp_f32_e64 v44, v44 clamp
    v_exp_f32_e64 v45, v45 clamp
    v_exp_f32_e64 v46, v46 clamp
    v_mfma_f32_32x32x16_bf16 v[144:159], a[204:207], a[228:231], v[144:159]
    v_exp_f32_e64 v47, v47 clamp
    v_max_f32 v68, v43, v68
    v_max_f32 v69, v43, v69
    v_max_f32 v70, v43, v70
    s_waitcnt lgkmcnt(4)
    v_mfma_f32_32x32x16_bf16 v[128:143], a[208:211], a[232:235], v[128:143]
    ds_read_b64_tr_b16 a[248:249], v16 offset:10240
    ds_read_b64_tr_b16 a[250:251], v16 offset:10752
    v_max_f32 v71, v43, v71
    v_add_f32 v68, v68, v44
    v_add_f32 v69, v69, v45
    v_add_f32 v70, v70, v46
    v_mfma_f32_32x32x16_bf16 v[144:159], a[212:215], a[232:235], v[144:159]
    ds_read_b64_tr_b16 a[252:253], v16 offset:11264
    ds_read_b64_tr_b16 a[254:255], v16 offset:11776
    v_add_f32 v71, v71, v47
    v_cvt_pk_bf16_f32 v66, v68, v69
    v_cvt_pk_bf16_f32 v67, v70, v71
    v_fmaak_f32 v44, v72, v42, 0xb5c1a2a0
    v_mfma_f32_32x32x16_bf16 v[128:143], a[216:219], a[236:239], v[128:143]
    v_fmaak_f32 v45, v73, v42, 0xb5c1a2a0
    v_fmaak_f32 v46, v74, v42, 0xb5c1a2a0
    v_fmaak_f32 v47, v75, v42, 0xb5c1a2a0
    v_exp_f32_e64 v44, v44 clamp
    v_mfma_f32_32x32x16_bf16 v[144:159], a[220:223], a[236:239], v[144:159]
    v_exp_f32_e64 v45, v45 clamp
    v_exp_f32_e64 v46, v46 clamp
    s_waitcnt lgkmcnt(4)
    s_barrier
    v_mfma_f32_32x32x16_bf16 v[160:175], a[192:195], a[240:243], v[160:175]
    ds_read_b64_tr_b16 a[224:225], v15 offset:16384
    ds_read_b64_tr_b16 a[226:227], v15 offset:16896
    v_exp_f32_e64 v47, v47 clamp
    v_max_f32 v72, v43, v72
    v_max_f32 v73, v43, v73
    v_mfma_f32_32x32x16_bf16 v[176:191], a[196:199], a[240:243], v[176:191]
    ds_read_b64_tr_b16 a[228:229], v16 offset:16384
    ds_read_b64_tr_b16 a[230:231], v16 offset:16896
    v_max_f32 v74, v43, v74
    v_max_f32 v75, v43, v75
    v_add_f32 v72, v72, v44
    v_add_f32 v73, v73, v45
    v_mfma_f32_32x32x16_bf16 v[160:175], a[200:203], a[244:247], v[160:175]
    v_add_f32 v74, v74, v46
    v_add_f32 v75, v75, v47
    v_cvt_pk_bf16_f32 v68, v72, v73
    v_cvt_pk_bf16_f32 v69, v74, v75
    v_fmaak_f32 v44, v76, v42, 0xb5c1a2a0
    v_fmaak_f32 v45, v77, v42, 0xb5c1a2a0
    v_mfma_f32_32x32x16_bf16 v[176:191], a[204:207], a[244:247], v[176:191]
    v_fmaak_f32 v46, v78, v42, 0xb5c1a2a0
    v_fmaak_f32 v47, v79, v42, 0xb5c1a2a0
    v_exp_f32_e64 v44, v44 clamp
    s_waitcnt lgkmcnt(4)
    v_mfma_f32_32x32x16_bf16 v[160:175], a[208:211], a[248:251], v[160:175]
    ds_read_b64_tr_b16 a[232:233], v16 offset:17408
    ds_read_b64_tr_b16 a[234:235], v16 offset:17920
    v_exp_f32_e64 v45, v45 clamp
    v_exp_f32_e64 v46, v46 clamp
    v_mfma_f32_32x32x16_bf16 v[176:191], a[212:215], a[248:251], v[176:191]
    ds_read_b64_tr_b16 a[236:237], v16 offset:18432
    ds_read_b64_tr_b16 a[238:239], v16 offset:18944
    v_exp_f32_e64 v47, v47 clamp
    v_max_f32 v76, v43, v76
    v_max_f32 v77, v43, v77
    v_mfma_f32_32x32x16_bf16 v[160:175], a[216:219], a[252:255], v[160:175]
    v_max_f32 v78, v43, v78
    v_max_f32 v79, v43, v79
    v_add_f32 v76, v76, v44
    v_add_f32 v77, v77, v45
    v_add_f32 v78, v78, v46
    v_add_f32 v79, v79, v47
    v_mfma_f32_32x32x16_bf16 v[176:191], a[220:223], a[252:255], v[176:191]
    v_cvt_pk_bf16_f32 v70, v76, v77
    v_cvt_pk_bf16_f32 v71, v78, v79
    v_fmaak_f32 v48, v80, v42, 0xb5c1a2a0
    v_fmaak_f32 v49, v81, v42, 0xb5c1a2a0
    v_fmaak_f32 v50, v82, v42, 0xb5c1a2a0
    s_waitcnt lgkmcnt(4)
    v_mfma_f32_32x32x16_bf16 v[240:255], a[224:227], a[4:7], v[192:207]
    ds_read_b64_tr_b16 a[240:241], v16 offset:19456
    v_fmaak_f32 v51, v83, v42, 0xb5c1a2a0
    v_exp_f32_e64 v48, v48 clamp
    v_exp_f32_e64 v49, v49 clamp
    v_exp_f32_e64 v50, v50 clamp
    v_mfma_f32_32x32x16_bf16 v[224:239], a[224:227], a[0:3], v[192:207]
    ds_read_b64_tr_b16 a[242:243], v16 offset:19968
    v_exp_f32_e64 v51, v51 clamp
    v_max_f32 v80, v43, v80
    v_max_f32 v81, v43, v81
    v_max_f32 v82, v43, v82
    v_max_f32 v83, v43, v83
    v_add_f32 v80, v80, v48
    v_add_f32 v81, v81, v49
    v_mfma_f32_32x32x16_bf16 v[208:223], a[228:231], a[4:7], v[192:207]
    ds_read_b64_tr_b16 a[244:245], v16 offset:24576
    v_add_f32 v82, v82, v50
    v_add_f32 v83, v83, v51
    v_cvt_pk_bf16_f32 v72, v80, v81
    v_cvt_pk_bf16_f32 v73, v82, v83
    v_fmaak_f32 v48, v84, v42, 0xb5c1a2a0
    v_fmaak_f32 v49, v85, v42, 0xb5c1a2a0
    v_fmaak_f32 v50, v86, v42, 0xb5c1a2a0
    v_fmaak_f32 v51, v87, v42, 0xb5c1a2a0
    v_mfma_f32_32x32x16_bf16 v[192:207], a[228:231], a[0:3], v[192:207]
    ds_read_b64_tr_b16 a[246:247], v16 offset:25088
    v_exp_f32_e64 v48, v48 clamp
    v_exp_f32_e64 v49, v49 clamp
    v_exp_f32_e64 v50, v50 clamp
    s_waitcnt lgkmcnt(4)
    v_mfma_f32_32x32x16_bf16 v[208:223], a[232:235], a[12:15], v[208:223]
    ds_read_b64_tr_b16 a[248:249], v16 offset:25600
    v_exp_f32_e64 v51, v51 clamp
    v_max_f32 v84, v43, v84
    v_max_f32 v85, v43, v85
    v_max_f32 v86, v43, v86
    v_max_f32 v87, v43, v87
    v_add_f32 v84, v84, v48
    v_add_f32 v85, v85, v49
    v_mfma_f32_32x32x16_bf16 v[192:207], a[232:235], a[8:11], v[192:207]
    ds_read_b64_tr_b16 a[250:251], v16 offset:26112
    v_add_f32 v86, v86, v50
    v_add_f32 v87, v87, v51
    v_cvt_pk_bf16_f32 v74, v84, v85
    v_cvt_pk_bf16_f32 v75, v86, v87
    v_fmaak_f32 v48, v88, v42, 0xb5c1a2a0
    v_fmaak_f32 v49, v89, v42, 0xb5c1a2a0
    v_fmaak_f32 v50, v90, v42, 0xb5c1a2a0
    v_fmaak_f32 v51, v91, v42, 0xb5c1a2a0
    v_mfma_f32_32x32x16_bf16 v[208:223], a[236:239], a[20:23], v[208:223]
    ds_read_b64_tr_b16 a[252:253], v16 offset:26624
    v_exp_f32_e64 v48, v48 clamp
    v_exp_f32_e64 v49, v49 clamp
    v_exp_f32_e64 v50, v50 clamp
    v_exp_f32_e64 v51, v51 clamp
    v_mfma_f32_32x32x16_bf16 v[192:207], a[236:239], a[16:19], v[192:207]
    ds_read_b64_tr_b16 a[254:255], v16 offset:27136
    v_max_f32 v88, v43, v88
    v_max_f32 v89, v43, v89
    v_max_f32 v90, v43, v90
    v_max_f32 v91, v43, v91
    v_add_f32 v88, v88, v48
    v_add_f32 v89, v89, v49
    v_add_f32 v90, v90, v50
    s_waitcnt lgkmcnt(4)
    v_mfma_f32_32x32x16_bf16 v[208:223], a[240:243], a[28:31], v[208:223]
    ds_read_b64_tr_b16 a[224:225], v16 offset:27648
    v_add_f32 v91, v91, v51
    v_cvt_pk_bf16_f32 v76, v88, v89
    v_cvt_pk_bf16_f32 v77, v90, v91
    v_fmaak_f32 v48, v92, v42, 0xb5c1a2a0
    v_fmaak_f32 v49, v93, v42, 0xb5c1a2a0
    v_fmaak_f32 v50, v94, v42, 0xb5c1a2a0
    v_fmaak_f32 v51, v95, v42, 0xb5c1a2a0
    v_mfma_f32_32x32x16_bf16 v[192:207], a[240:243], a[24:27], v[192:207]
    ds_read_b64_tr_b16 a[226:227], v16 offset:28160
    v_exp_f32_e64 v48, v48 clamp
    v_exp_f32_e64 v49, v49 clamp
    v_exp_f32_e64 v50, v50 clamp
    v_exp_f32_e64 v51, v51 clamp
    v_mfma_f32_32x32x16_bf16 v[208:223], a[244:247], a[36:39], v[208:223]
    ds_read_b64_tr_b16 a[228:229], v16 offset:32768
    v_max_f32 v92, v43, v92
    v_max_f32 v93, v43, v93
    v_max_f32 v94, v43, v94
    v_max_f32 v95, v43, v95
    v_add_f32 v92, v92, v48
    v_add_f32 v93, v93, v49
    v_add_f32 v94, v94, v50
    v_add_f32 v95, v95, v51
    v_mfma_f32_32x32x16_bf16 v[192:207], a[244:247], a[32:35], v[192:207]
    ds_read_b64_tr_b16 a[230:231], v16 offset:33280
    v_cvt_pk_bf16_f32 v78, v92, v93
L_pad_att_1:
    s_cbranch_execz L_att_main
    v_cvt_pk_bf16_f32 v79, v94, v95
    v_cvt_pk_bf16_f32 v128, v128, v129
    v_cvt_pk_bf16_f32 v129, v130, v131
    v_cvt_pk_bf16_f32 v130, v132, v133
    v_cvt_pk_bf16_f32 v131, v134, v135
    v_cvt_pk_bf16_f32 v132, v136, v137
    s_waitcnt lgkmcnt(4)
    v_mfma_f32_32x32x16_bf16 v[208:223], a[248:251], a[44:47], v[208:223]
    ds_read_b64_tr_b16 a[232:233], v16 offset:33792
    v_cvt_pk_bf16_f32 v133, v138, v139
    v_cvt_pk_bf16_f32 v134, v140, v141
    v_cvt_pk_bf16_f32 v135, v142, v143
    v_cvt_pk_bf16_f32 v144, v144, v145
    v_cvt_pk_bf16_f32 v145, v146, v147
    v_cvt_pk_bf16_f32 v146, v148, v149
    v_cvt_pk_bf16_f32 v147, v150, v151
    v_cvt_pk_bf16_f32 v148, v152, v153
    v_mfma_f32_32x32x16_bf16 v[192:207], a[248:251], a[40:43], v[192:207]
    ds_read_b64_tr_b16 a[234:235], v16 offset:34304
    v_cvt_pk_bf16_f32 v149, v154, v155
    v_cvt_pk_bf16_f32 v150, v156, v157
    v_cvt_pk_bf16_f32 v151, v158, v159
    v_fmaak_f32 v44, v96, v42, 0xb5c1a2a0
    v_fmaak_f32 v45, v97, v42, 0xb5c1a2a0
    v_mfma_f32_32x32x16_bf16 v[208:223], a[252:255], a[52:55], v[208:223]
    ds_read_b64_tr_b16 a[236:237], v16 offset:34816
    v_mfma_f32_32x32x16_bf16 v[80:95], v[64:67], v[128:131], 0
    v_fmaak_f32 v46, v98, v42, 0xb5c1a2a0
    v_fmaak_f32 v47, v99, v42, 0xb5c1a2a0
    v_exp_f32_e64 v44, v44 clamp
    v_exp_f32_e64 v45, v45 clamp
    v_exp_f32_e64 v46, v46 clamp
    v_mfma_f32_32x32x16_bf16 v[80:95], v[68:71], v[132:135], v[80:95]
    v_exp_f32_e64 v47, v47 clamp
    v_max_f32 v96, v43, v96
    v_max_f32 v97, v43, v97
    v_max_f32 v98, v43, v98
    v_max_f32 v99, v43, v99
    v_add_f32 v96, v96, v44
    v_add_f32 v97, v97, v45
    v_add_f32 v98, v98, v46
    v_mfma_f32_32x32x16_bf16 v[80:95], v[72:75], v[144:147], v[80:95]
    v_add_f32 v99, v99, v47
    v_cvt_pk_bf16_f32 v96, v96, v97
    v_cvt_pk_bf16_f32 v97, v98, v99
    v_fmaak_f32 v44, v100, v42, 0xb5c1a2a0
    v_fmaak_f32 v45, v101, v42, 0xb5c1a2a0
    v_fmaak_f32 v46, v102, v42, 0xb5c1a2a0
    v_fmaak_f32 v47, v103, v42, 0xb5c1a2a0
    v_exp_f32_e64 v44, v44 clamp
    v_mfma_f32_32x32x16_bf16 v[80:95], v[76:79], v[148:151], v[80:95]
    v_exp_f32_e64 v45, v45 clamp
    v_exp_f32_e64 v46, v46 clamp
    v_exp_f32_e64 v47, v47 clamp
    v_max_f32 v100, v43, v100
    v_max_f32 v101, v43, v101
    v_max_f32 v102, v43, v102
    v_mfma_f32_32x32x16_bf16 v[192:207], a[252:255], a[48:51], v[192:207]
    ds_read_b64_tr_b16 a[238:239], v16 offset:35328
    v_max_f32 v103, v43, v103
    v_add_f32 v100, v100, v44
    v_add_f32 v101, v101, v45
    v_add_f32 v102, v102, v46
    v_add_f32 v103, v103, v47
    v_cvt_pk_bf16_f32 v98, v100, v101
    v_cvt_pk_bf16_f32 v99, v102, v103
    s_waitcnt vmcnt(0)
    ds_write_b64 v19, v[34:35] offset:49152
    s_waitcnt lgkmcnt(5)
    v_mfma_f32_32x32x16_bf16 v[208:223], a[224:227], a[60:63], v[208:223]
    ds_read_b64_tr_b16 a[240:241], v16 offset:35840
    v_fmaak_f32 v44, v104, v42, 0xb5c1a2a0
    v_fmaak_f32 v45, v105, v42, 0xb5c1a2a0
    v_fmaak_f32 v46, v106, v42, 0xb5c1a2a0
    v_fmaak_f32 v47, v107, v42, 0xb5c1a2a0
    v_exp_f32_e64 v44, v44 clamp
    v_exp_f32_e64 v45, v45 clamp
    v_mfma_f32_32x32x16_bf16 v[192:207], a[224:227], a[56:59], v[192:207]
    ds_read_b64_tr_b16 a[242:243], v16 offset:36352
    v_exp_f32_e64 v46, v46 clamp
    v_exp_f32_e64 v47, v47 clamp
    v_max_f32 v104, v43, v104
    v_max_f32 v105, v43, v105
    v_max_f32 v106, v43, v106
    v_max_f32 v107, v43, v107
    v_mfma_f32_32x32x16_bf16 v[208:223], a[228:231], a[68:71], v[208:223]
    ds_read_b64_tr_b16 a[244:245], v16 offset:40960
    v_add_f32 v104, v104, v44
    v_add_f32 v105, v105, v45
    v_add_f32 v106, v106, v46
    v_add_f32 v107, v107, v47
    v_cvt_pk_bf16_f32 v100, v104, v105
    v_cvt_pk_bf16_f32 v101, v106, v107
    v_fmaak_f32 v44, v108, v42, 0xb5c1a2a0
    v_fmaak_f32 v45, v109, v42, 0xb5c1a2a0
    v_mfma_f32_32x32x16_bf16 v[192:207], a[228:231], a[64:67], v[192:207]
    ds_read_b64_tr_b16 a[246:247], v16 offset:41472
    v_fmaak_f32 v46, v110, v42, 0xb5c1a2a0
    v_fmaak_f32 v47, v111, v42, 0xb5c1a2a0
    v_exp_f32_e64 v44, v44 clamp
    v_exp_f32_e64 v45, v45 clamp
    s_waitcnt lgkmcnt(5)
    v_mfma_f32_32x32x16_bf16 v[208:223], a[232:235], a[76:79], v[208:223]
    ds_read_b64_tr_b16 a[248:249], v16 offset:41984
    v_exp_f32_e64 v46, v46 clamp
    v_exp_f32_e64 v47, v47 clamp
    v_max_f32 v108, v43, v108
    v_max_f32 v109, v43, v109
    ds_write_b128 v60, v[80:83] offset:0
    v_mfma_f32_32x32x16_bf16 v[192:207], a[232:235], a[72:75], v[192:207]
    ds_read_b64_tr_b16 a[250:251], v16 offset:42496
    v_max_f32 v110, v43, v110
    v_max_f32 v111, v43, v111
    v_add_f32 v108, v108, v44
    v_add_f32 v109, v109, v45
    v_add_f32 v110, v110, v46
    v_add_f32 v111, v111, v47
    v_cvt_pk_bf16_f32 v102, v108, v109
    v_cvt_pk_bf16_f32 v103, v110, v111
    v_mfma_f32_32x32x16_bf16 v[208:223], a[236:239], a[84:87], v[208:223]
    ds_read_b64_tr_b16 a[252:253], v16 offset:43008
    v_fmaak_f32 v48, v112, v42, 0xb5c1a2a0
    v_fmaak_f32 v49, v113, v42, 0xb5c1a2a0
    v_fmaak_f32 v50, v114, v42, 0xb5c1a2a0
    v_fmaak_f32 v51, v115, v42, 0xb5c1a2a0
    ds_write_b128 v60, v[84:87] offset:1024
    v_exp_f32_e64 v48, v48 clamp
    v_mfma_f32_32x32x16_bf16 v[192:207], a[236:239], a[80:83], v[192:207]
    ds_read_b64_tr_b16 a[254:255], v16 offset:43520
    v_exp_f32_e64 v49, v49 clamp
    v_exp_f32_e64 v50, v50 clamp
    v_exp_f32_e64 v51, v51 clamp
    v_max_f32 v112, v43, v112
    s_waitcnt lgkmcnt(10)
    s_barrier
    s_waitcnt lgkmcnt(6)
    v_mfma_f32_32x32x16_bf16 v[208:223], a[240:243], a[92:95], v[208:223]
    ds_read_b64_tr_b16 a[224:225], v16 offset:44032
    v_max_f32 v113, v43, v113
    v_max_f32 v114, v43, v114
    v_max_f32 v115, v43, v115
    v_add_f32 v112, v112, v48
    v_add_f32 v113, v113, v49
    v_add_f32 v114, v114, v50
    v_add_f32 v115, v115, v51
    v_mfma_f32_32x32x16_bf16 v[192:207], a[240:243], a[88:91], v[192:207]
    ds_read_b64_tr_b16 a[226:227], v16 offset:44544
    ds_write_b128 v60, v[88:91] offset:2048
    v_cvt_pk_bf16_f32 v104, v112, v113
    v_cvt_pk_bf16_f32 v105, v114, v115
    v_fmaak_f32 v48, v116, v42, 0xb5c1a2a0
    v_fmaak_f32 v49, v117, v42, 0xb5c1a2a0
    v_fmaak_f32 v50, v118, v42, 0xb5c1a2a0
    v_fmaak_f32 v51, v119, v42, 0xb5c1a2a0
    v_mfma_f32_32x32x16_bf16 v[208:223], a[244:247], a[100:103], v[208:223]
    ds_read_b64_tr_b16 a[228:229], v18 offset:0
    v_exp_f32_e64 v48, v48 clamp
    v_exp_f32_e64 v49, v49 clamp
    v_exp_f32_e64 v50, v50 clamp
    v_exp_f32_e64 v51, v51 clamp
    v_mfma_f32_32x32x16_bf16 v[192:207], a[244:247], a[96:99], v[192:207]
    ds_read_b64_tr_b16 a[230:231], v18 offset:512
    v_max_f32 v116, v43, v116
    v_max_f32 v117, v43, v117
    ds_write_b128 v60, v[92:95] offset:3072
    v_max_f32 v118, v43, v118
    v_max_f32 v119, v43, v119
    v_add_f32 v116, v116, v48
    s_waitcnt lgkmcnt(6)
    v_mfma_f32_32x32x16_bf16 v[208:223], a[248:251], a[108:111], v[208:223]
    ds_read_b64_tr_b16 a[232:233], v18 offset:1024
    v_add_f32 v117, v117, v49
    v_add_f32 v118, v118, v50
    v_add_f32 v119, v119, v51
    v_cvt_pk_bf16_f32 v106, v116, v117
    v_cvt_pk_bf16_f32 v107, v118, v119
    v_fmaak_f32 v48, v120, v42, 0xb5c1a2a0
    v_fmaak_f32 v49, v121, v42, 0xb5c1a2a0
    v_fmaak_f32 v50, v122, v42, 0xb5c1a2a0
    v_mfma_f32_32x32x16_bf16 v[192:207], a[248:251], a[104:107], v[192:207]
    ds_read_b64_tr_b16 a[234:235], v18 offset:1536
    v_fmaak_f32 v51, v123, v42, 0xb5c1a2a0
    v_exp_f32_e64 v48, v48 clamp
    v_exp_f32_e64 v49, v49 clamp
    v_exp_f32_e64 v50, v50 clamp
    v_mfma_f32_32x32x16_bf16 v[208:223], a[252:255], a[116:119], v[208:223]
    ds_read_b64_tr_b16 a[236:237], v18 offset:2048
    v_exp_f32_e64 v51, v51 clamp
    v_max_f32 v120, v43, v120
    v_max_f32 v121, v43, v121
    v_max_f32 v122, v43, v122
    v_max_f32 v123, v43, v123
    v_add_f32 v120, v120, v48
    v_add_f32 v121, v121, v49
    v_mfma_f32_32x32x16_bf16 v[192:207], a[252:255], a[112:115], v[192:207]
    ds_read_b64_tr_b16 a[238:239], v18 offset:2560
    v_add_f32 v122, v122, v50
    v_add_f32 v123, v123, v51
    v_cvt_pk_bf16_f32 v108, v120, v121
    v_cvt_pk_bf16_f32 v109, v122, v123
    v_fmaak_f32 v48, v124, v42, 0xb5c1a2a0
    v_fmaak_f32 v49, v125, v42, 0xb5c1a2a0
    v_fmaak_f32 v50, v126, v42, 0xb5c1a2a0
    buffer_load_dword v39, v38, s[28:31], 0 offen sc1
    s_waitcnt lgkmcnt(5)
    v_mfma_f32_32x32x16_bf16 v[208:223], a[224:227], a[124:127], v[208:223]
    ds_read_b64_tr_b16 a[240:241], v18 offset:3072
    v_fmaak_f32 v51, v127, v42, 0xb5c1a2a0
    v_exp_f32_e64 v48, v48 clamp
    v_exp_f32_e64 v49, v49 clamp
    v_exp_f32_e64 v50, v50 clamp
    v_mfma_f32_32x32x16_bf16 v[192:207], a[224:227], a[120:123], v[192:207]
    ds_read_b64_tr_b16 a[242:243], v18 offset:3584
    v_exp_f32_e64 v51, v51 clamp
    v_max_f32 v124, v43, v124
    v_max_f32 v125, v43, v125
    v_max_f32 v126, v43, v126
    v_max_f32 v127, v43, v127
    v_add_f32 v124, v124, v48
    v_add_f32 v125, v125, v49
    v_mfma_f32_32x32x16_bf16 v[208:223], a[228:231], a[132:135], v[208:223]
    ds_read_b64_tr_b16 a[244:245], v18 offset:8192
    v_add_f32 v126, v126, v50
    v_add_f32 v127, v127, v51
    v_cvt_pk_bf16_f32 v110, v124, v125
    v_cvt_pk_bf16_f32 v111, v126, v127
    v_cvt_pk_bf16_f32 v160, v160, v161
    v_cvt_pk_bf16_f32 v161, v162, v163
    v_cvt_pk_bf16_f32 v162, v164, v165
    v_cvt_pk_bf16_f32 v163, v166, v167
    v_mfma_f32_32x32x16_bf16 v[192:207], a[228:231], a[128:131], v[192:207]
    ds_read_b64_tr_b16 a[246:247], v18 offset:8704
    v_cvt_pk_bf16_f32 v164, v168, v169
    v_cvt_pk_bf16_f32 v165, v170, v171
    v_cvt_pk_bf16_f32 v166, v172, v173
    v_cvt_pk_bf16_f32 v167, v174, v175
    v_cvt_pk_bf16_f32 v176, v176, v177
    v_cvt_pk_bf16_f32 v177, v178, v179
    v_cvt_pk_bf16_f32 v178, v180, v181
    s_waitcnt lgkmcnt(4)
    v_mfma_f32_32x32x16_bf16 v[208:223], a[232:235], a[140:143], v[208:223]
    ds_read_b64_tr_b16 a[248:249], v18 offset:9216
    v_cvt_pk_bf16_f32 v179, v182, v183
    v_cvt_pk_bf16_f32 v180, v184, v185
    v_cvt_pk_bf16_f32 v181, v186, v187
    v_cvt_pk_bf16_f32 v182, v188, v189
    v_cvt_pk_bf16_f32 v183, v190, v191
    s_nop 1
    v_mfma_f32_32x32x16_bf16 v[192:207], a[232:235], a[136:139], v[192:207]
    ds_read_b64_tr_b16 a[250:251], v18 offset:9728
    v_mfma_f32_32x32x16_bf16 v[112:127], v[96:99], v[160:163], 0
    v_mfma_f32_32x32x16_bf16 v[112:127], v[100:103], v[164:167], v[112:127]
    v_mfma_f32_32x32x16_bf16 v[112:127], v[104:107], v[176:179], v[112:127]
    v_mfma_f32_32x32x16_bf16 v[112:127], v[108:111], v[180:183], v[112:127]
    v_mfma_f32_32x32x16_bf16 v[208:223], a[236:239], a[148:151], v[208:223]
    ds_read_b64_tr_b16 a[252:253], v18 offset:10240
    v_mfma_f32_32x32x16_bf16 v[192:207], a[236:239], a[144:147], v[192:207]
    ds_read_b64_tr_b16 a[254:255], v18 offset:10752
    s_waitcnt lgkmcnt(4)
    v_mfma_f32_32x32x16_bf16 v[208:223], a[240:243], a[156:159], v[208:223]
    ds_read_b64_tr_b16 a[224:225], v18 offset:11264
    ds_write_b128 v60, v[112:115] offset:4096
    ds_write_b128 v60, v[116:119] offset:5120
    v_mfma_f32_32x32x16_bf16 v[192:207], a[240:243], a[152:155], v[192:207]
    ds_read_b64_tr_b16 a[226:227], v18 offset:11776
    v_mfma_f32_32x32x16_bf16 v[208:223], a[244:247], a[164:167], v[208:223]
    ds_read_b64_tr_b16 a[228:229], v18 offset:16384
    ds_write_b128 v60, v[120:123] offset:6144
    ds_write_b128 v60, v[124:127] offset:7168
    v_mfma_f32_32x32x16_bf16 v[192:207], a[244:247], a[160:163], v[192:207]
    ds_read_b64_tr_b16 a[230:231], v18 offset:16896
    s_waitcnt lgkmcnt(8)
    v_mfma_f32_32x32x16_bf16 v[208:223], a[248:251], a[172:175], v[208:223]
    ds_read_b64_tr_b16 a[232:233], v18 offset:17408
    v_mfma_f32_32x32x16_bf16 v[192:207], a[248:251], a[168:171], v[192:207]
    ds_read_b64_tr_b16 a[234:235], v18 offset:17920
    s_waitcnt lgkmcnt(3)
    s_barrier
    ds_read_b128 v[128:131], v61 offset:0
    ds_read_b128 v[132:135], v61 offset:1024
    ds_read_b128 v[136:139], v61 offset:8192
    ds_read_b128 v[140:143], v61 offset:9216
    ds_read_b128 v[144:147], v61 offset:16384
    ds_read_b128 v[148:151], v61 offset:17408
    ds_read_b128 v[152:155], v61 offset:24576
    v_mfma_f32_32x32x16_bf16 v[208:223], a[252:255], a[180:183], v[208:223]
    ds_read_b64_tr_b16 a[236:237], v18 offset:18432
    ds_read_b128 v[156:159], v61 offset:25600
    v_mfma_f32_32x32x16_bf16 v[192:207], a[252:255], a[176:179], v[192:207]
    ds_read_b64_tr_b16 a[238:239], v18 offset:18944
    s_waitcnt lgkmcnt(12)
    v_mfma_f32_32x32x16_bf16 v[208:223], a[224:227], a[188:191], v[208:223]
    ds_read_b64_tr_b16 a[240:241], v18 offset:19456
    v_mfma_f32_32x32x16_bf16 v[192:207], a[224:227], a[184:187], v[192:207]
    ds_read_b64_tr_b16 a[242:243], v18 offset:19968
    s_waitcnt lgkmcnt(3)
    v_add_f32 v128, v128, v136
    v_add_f32 v129, v129, v137
    v_add_f32 v130, v130, v138
    v_add_f32 v131, v131, v139
    v_add_f32 v132, v132, v140
    v_add_f32 v133, v133, v141
    v_add_f32 v134, v134, v142
    v_mfma_f32_32x32x16_bf16 v[208:223], a[228:231], a[196:199], v[208:223]
    ds_read_b64_tr_b16 a[244:245], v15 offset:17408
    v_add_f32 v135, v135, v143
    v_add_f32 v144, v144, v152
    v_add_f32 v145, v145, v153
    v_add_f32 v146, v146, v154
    v_add_f32 v147, v147, v155
    v_add_f32 v148, v148, v156
    v_add_f32 v149, v149, v157
    v_add_f32 v150, v150, v158
    v_mfma_f32_32x32x16_bf16 v[192:207], a[228:231], a[192:195], v[192:207]
    ds_read_b64_tr_b16 a[246:247], v15 offset:17920
    v_add_f32 v151, v151, v159
    v_add_f32 v128, v128, v144
    v_add_f32 v129, v129, v145
    v_add_f32 v130, v130, v146
    v_add_f32 v131, v131, v147
    v_add_f32 v132, v132, v148
    v_add_f32 v133, v133, v149
    s_waitcnt lgkmcnt(4)
    v_mfma_f32_32x32x16_bf16 v[208:223], a[232:235], a[204:207], v[208:223]
    ds_read_b64_tr_b16 a[248:249], v15 offset:18432
    v_add_f32 v134, v134, v150
    v_add_f32 v135, v135, v151
    v_cvt_pk_bf16_f32 v128, v128, v129
    v_cvt_pk_bf16_f32 v129, v130, v131
    v_cvt_pk_bf16_f32 v130, v132, v133
    v_cvt_pk_bf16_f32 v131, v134, v135
    v_mfma_f32_32x32x16_bf16 v[192:207], a[232:235], a[200:203], v[192:207]
    ds_read_b64_tr_b16 a[250:251], v15 offset:18944
    buffer_store_dwordx4 v[128:131], v40, s[28:31], s68 offen offset:0 sc1
    v_mfma_f32_32x32x16_bf16 v[208:223], a[236:239], a[212:215], v[208:223]
    ds_read_b64_tr_b16 a[252:253], v15 offset:19456
    buffer_store_dwordx4 v[56:59], v41, s[28:31], s70 offen offset:0 sc1
    v_mfma_f32_32x32x16_bf16 v[192:207], a[236:239], a[208:211], v[192:207]
    ds_read_b64_tr_b16 a[254:255], v15 offset:19968
    s_waitcnt lgkmcnt(4)
    v_mfma_f32_32x32x16_bf16 v[208:223], a[240:243], a[220:223], v[208:223]
    ds_read_b64_tr_b16 a[224:225], v15 offset:24576
    buffer_store_dwordx4 v[56:59], v41, s[28:31], s70 offen offset:512 sc1
    v_mfma_f32_32x32x16_bf16 v[192:207], a[240:243], a[216:219], v[192:207]
    ds_read_b64_tr_b16 a[226:227], v15 offset:25088
    v_mfma_f32_32x32x16_bf16 v[240:255], a[244:247], a[12:15], v[240:255]
    ds_read_b64_tr_b16 a[228:229], v15 offset:25600
    buffer_store_dwordx4 v[56:59], v41, s[28:31], s70 offen offset:1024 sc1
    v_mfma_f32_32x32x16_bf16 v[224:239], a[244:247], a[8:11], v[224:239]
    ds_read_b64_tr_b16 a[230:231], v15 offset:26112
    s_waitcnt lgkmcnt(4)
    v_mfma_f32_32x32x16_bf16 v[240:255], a[248:251], a[20:23], v[240:255]
    ds_read_b64_tr_b16 a[232:233], v15 offset:26624
    buffer_store_dwordx4 v[56:59], v41, s[28:31], s70 offen offset:1536 sc1
    v_mfma_f32_32x32x16_bf16 v[224:239], a[248:251], a[16:19], v[224:239]
    ds_read_b64_tr_b16 a[234:235], v15 offset:27136
    v_mov_b32 v26, 0x3f80
    v_and_b32 v24, 31, v0
    v_lshlrev_b32 v25, 2, v27
    v_sub_u32 v24, v24, v25
    v_and_b32 v25, 1, v24
    v_mfma_f32_32x32x16_bf16 v[240:255], a[252:255], a[28:31], v[240:255]
    ds_read_b64_tr_b16 a[236:237], v15 offset:27648
    buffer_store_dwordx4 v[56:59], v41, s[28:31], s71 offen offset:0 sc1
    v_mfma_f32_32x32x16_bf16 v[224:239], a[252:255], a[24:27], v[224:239]
    ds_read_b64_tr_b16 a[238:239], v15 offset:28160
    v_lshlrev_b32 v25, 4, v25
    v_lshlrev_b32 v25, v25, v26
    v_lshrrev_b32 v24, 1, v24
    s_waitcnt lgkmcnt(4)
    v_mfma_f32_32x32x16_bf16 v[240:255], a[224:227], a[36:39], v[240:255]
    ds_read_b64_tr_b16 a[240:241], v15 offset:32768
    v_cmp_eq_u32 vcc, 0, v24
    s_nop 1
    v_cndmask_b32 v32, 0, v25, vcc
    v_mfma_f32_32x32x16_bf16 v[224:239], a[224:227], a[32:35], v[224:239]
    ds_read_b64_tr_b16 a[242:243], v15 offset:33280
    buffer_store_dwordx4 v[56:59], v41, s[28:31], s71 offen offset:512 sc1
    v_mfma_f32_32x32x16_bf16 v[240:255], a[228:231], a[44:47], v[240:255]
    ds_read_b64_tr_b16 a[244:245], v15 offset:33792
    v_cmp_eq_u32 vcc, 1, v24
    s_nop 1
    v_cndmask_b32 v33, 0, v25, vcc
    v_mfma_f32_32x32x16_bf16 v[224:239], a[228:231], a[40:43], v[224:239]
    ds_read_b64_tr_b16 a[246:247], v15 offset:34304
    buffer_store_dwordx4 v[56:59], v41, s[28:31], s71 offen offset:1024 sc1
    s_waitcnt lgkmcnt(4)
    v_mfma_f32_32x32x16_bf16 v[240:255], a[232:235], a[52:55], v[240:255]
    ds_read_b64_tr_b16 a[248:249], v15 offset:34816
    v_cmp_eq_u32 vcc, 4, v24
    s_nop 1
    v_cndmask_b32 v34, 0, v25, vcc
    v_mfma_f32_32x32x16_bf16 v[224:239], a[232:235], a[48:51], v[224:239]
    ds_read_b64_tr_b16 a[250:251], v15 offset:35328
    buffer_store_dwordx4 v[56:59], v41, s[28:31], s71 offen offset:1536 sc1
    v_mfma_f32_32x32x16_bf16 v[240:255], a[236:239], a[60:63], v[240:255]
    ds_read_b64_tr_b16 a[252:253], v15 offset:35840
    v_cmp_eq_u32 vcc, 5, v24
    s_nop 1
    v_cndmask_b32 v35, 0, v25, vcc
    v_mfma_f32_32x32x16_bf16 v[224:239], a[236:239], a[56:59], v[224:239]
    ds_read_b64_tr_b16 a[254:255], v15 offset:36352
    s_waitcnt lgkmcnt(4)
    v_mfma_f32_32x32x16_bf16 v[240:255], a[240:243], a[68:71], v[240:255]
    ds_read_b64_tr_b16 a[224:225], v15 offset:40960
    v_mov_b32 v36, v42
    v_mov_b32 v37, 0xb5c1a2a0
    v_mov_b32 v54, v220
    v_mov_b32 v55, v220
    v_fmaak_f32 v48, v208, v42, 0xb5c1a2a0
    v_mfma_f32_32x32x16_bf16 v[224:239], a[240:243], a[64:67], v[224:239]
    ds_read_b64_tr_b16 a[226:227], v15 offset:41472
    v_fmaak_f32 v49, v209, v42, 0xb5c1a2a0
    v_fmaak_f32 v50, v210, v42, 0xb5c1a2a0
    v_fmaak_f32 v51, v211, v42, 0xb5c1a2a0
    v_permlane32_swap_b32 v54, v55
    v_mfma_f32_32x32x16_bf16 v[240:255], a[244:247], a[76:79], v[240:255]
    ds_read_b64_tr_b16 a[228:229], v15 offset:41984
    v_exp_f32_e64 v48, v48 clamp
    v_exp_f32_e64 v49, v49 clamp
    v_mfma_f32_32x32x16_bf16 v[224:239], a[244:247], a[72:75], v[224:239]
    ds_read_b64_tr_b16 a[230:231], v15 offset:42496
    v_exp_f32_e64 v50, v50 clamp
    v_exp_f32_e64 v51, v51 clamp
    s_waitcnt lgkmcnt(4)
    v_mfma_f32_32x32x16_bf16 v[240:255], a[248:251], a[84:87], v[240:255]
    ds_read_b64_tr_b16 a[232:233], v15 offset:43008
    v_max_f32 v208, v43, v208
    v_max_f32 v209, v43, v209
    v_fmaak_f32 v54, v55, v42, 0xb5c1a2a0
    v_max_f32 v210, v43, v210
    v_max_f32 v211, v43, v211
    v_mfma_f32_32x32x16_bf16 v[224:239], a[248:251], a[80:83], v[224:239]
    ds_read_b64_tr_b16 a[234:235], v15 offset:43520
    v_exp_f32_e64 v54, -v54
    v_add_f32 v208, v208, v48
    v_add_f32 v209, v209, v49
    v_add_f32 v210, v210, v50
    v_mfma_f32_32x32x16_bf16 v[240:255], a[252:255], a[92:95], v[240:255]
    ds_read_b64_tr_b16 a[236:237], v15 offset:44032
    v_add_f32 v211, v211, v51
    v_add_f32 v54, 1.0, v54
    v_cvt_pk_bf16_f32 v208, v208, v209
    v_cvt_pk_bf16_f32 v209, v210, v211
    v_mfma_f32_32x32x16_bf16 v[224:239], a[252:255], a[88:91], v[224:239]
    ds_read_b64_tr_b16 a[238:239], v15 offset:44544
    v_rcp_f32 v55, v54
    v_fmaak_f32 v48, v212, v42, 0xb5c1a2a0
    v_fmaak_f32 v49, v213, v42, 0xb5c1a2a0
    s_waitcnt lgkmcnt(4)
    v_mfma_f32_32x32x16_bf16 v[240:255], a[224:227], a[100:103], v[240:255]
    ds_read_b64_tr_b16 a[240:241], v17 offset:0
    v_fmaak_f32 v50, v214, v42, 0xb5c1a2a0
    v_fmaak_f32 v51, v215, v42, 0xb5c1a2a0
    v_sub_f32 v54, 1.0, v55
    v_exp_f32_e64 v48, v48 clamp
    v_mfma_f32_32x32x16_bf16 v[224:239], a[224:227], a[96:99], v[224:239]
    ds_read_b64_tr_b16 a[242:243], v17 offset:512
    v_exp_f32_e64 v49, v49 clamp
    v_exp_f32_e64 v50, v50 clamp
    v_mfma_f32_32x32x16_bf16 v[240:255], a[228:231], a[108:111], v[240:255]
    ds_read_b64_tr_b16 a[244:245], v17 offset:1024
    v_exp_f32_e64 v51, v51 clamp
    v_max_f32 v212, v43, v212
    v_max_f32 v213, v43, v213
    v_max_f32 v214, v43, v214
    v_mfma_f32_32x32x16_bf16 v[224:239], a[228:231], a[104:107], v[224:239]
    ds_read_b64_tr_b16 a[246:247], v17 offset:1536
    v_max_f32 v215, v43, v215
    v_add_f32 v212, v212, v48
    v_add_f32 v213, v213, v49
    v_add_f32 v214, v214, v50
    s_waitcnt lgkmcnt(4)
    v_mfma_f32_32x32x16_bf16 v[240:255], a[232:235], a[116:119], v[240:255]
    ds_read_b64_tr_b16 a[248:249], v17 offset:2048
    v_add_f32 v215, v215, v51
    v_cvt_pk_bf16_f32 v210, v212, v213
    v_cvt_pk_bf16_f32 v211, v214, v215
    v_fmaak_f32 v48, v216, v42, 0xb5c1a2a0
    v_fmaak_f32 v49, v217, v42, 0xb5c1a2a0
    v_mfma_f32_32x32x16_bf16 v[224:239], a[232:235], a[112:115], v[224:239]
    ds_read_b64_tr_b16 a[250:251], v17 offset:2560
    v_fmaak_f32 v50, v218, v42, 0xb5c1a2a0
    v_fmaak_f32 v51, v219, v42, 0xb5c1a2a0
    v_exp_f32_e64 v48, v48 clamp
    v_mfma_f32_32x32x16_bf16 v[240:255], a[236:239], a[124:127], v[240:255]
    ds_read_b64_tr_b16 a[252:253], v17 offset:3072
    v_exp_f32_e64 v49, v49 clamp
    v_exp_f32_e64 v50, v50 clamp
    v_mfma_f32_32x32x16_bf16 v[224:239], a[236:239], a[120:123], v[224:239]
    ds_read_b64_tr_b16 a[254:255], v17 offset:3584
    v_exp_f32_e64 v51, v51 clamp
    v_max_f32 v216, v43, v216
    v_max_f32 v217, v43, v217
    s_waitcnt lgkmcnt(4)
    v_mfma_f32_32x32x16_bf16 v[240:255], a[240:243], a[132:135], v[240:255]
    ds_read_b64_tr_b16 a[224:225], v17 offset:8192
    v_max_f32 v218, v43, v218
    v_max_f32 v219, v43, v219
    v_add_f32 v216, v216, v48
    v_add_f32 v217, v217, v49
    v_add_f32 v218, v218, v50
    v_mfma_f32_32x32x16_bf16 v[224:239], a[240:243], a[128:131], v[224:239]
    ds_read_b64_tr_b16 a[226:227], v17 offset:8704
    v_add_f32 v219, v219, v51
    v_cvt_pk_bf16_f32 v212, v216, v217
    v_cvt_pk_bf16_f32 v213, v218, v219
    v_fmaak_f32 v48, v220, v42, 0xb5c1a2a0
    v_fmaak_f32 v49, v221, v42, 0xb5c1a2a0
    v_mfma_f32_32x32x16_bf16 v[240:255], a[244:247], a[140:143], v[240:255]
    ds_read_b64_tr_b16 a[228:229], v17 offset:9216
    v_fmaak_f32 v50, v222, v42, 0xb5c1a2a0
    v_fmaak_f32 v51, v223, v42, 0xb5c1a2a0
    v_exp_f32_e64 v48, v48 clamp
    v_mfma_f32_32x32x16_bf16 v[224:239], a[244:247], a[136:139], v[224:239]
    ds_read_b64_tr_b16 a[230:231], v17 offset:9728
    v_exp_f32_e64 v49, v49 clamp
    v_exp_f32_e64 v50, v50 clamp
    s_waitcnt vmcnt(9)
    v_cmp_ne_u32 vcc, 1, v39
    s_cbranch_vccnz L_slow_30
L_ok_32:
    s_waitcnt lgkmcnt(4)
    v_mfma_f32_32x32x16_bf16 v[240:255], a[248:251], a[148:151], v[240:255]
    ds_read_b64_tr_b16 a[232:233], v17 offset:10240
    s_mov_b32 s48, s69
    buffer_load_dwordx4 v[160:163], v40, s[28:31], s48 offen sc1
    v_exp_f32_e64 v51, v51 clamp
    v_mfma_f32_32x32x16_bf16 v[224:239], a[248:251], a[144:147], v[224:239]
    ds_read_b64_tr_b16 a[234:235], v17 offset:10752
    v_max_f32 v220, v43, v220
    v_max_f32 v221, v43, v221
    v_max_f32 v222, v43, v222
    v_max_f32 v223, v43, v223
    v_add_f32 v220, v220, v48
    v_mfma_f32_32x32x16_bf16 v[240:255], a[252:255], a[156:159], v[240:255]
    ds_read_b64_tr_b16 a[236:237], v17 offset:11264
    s_add_u32 s48, s48, 8192
    buffer_load_dwordx4 v[164:167], v40, s[28:31], s48 offen sc1
    v_add_f32 v221, v221, v49
    v_add_f32 v222, v222, v50
    v_mfma_f32_32x32x16_bf16 v[224:239], a[252:255], a[152:155], v[224:239]
    ds_read_b64_tr_b16 a[238:239], v17 offset:11776
    v_add_f32 v223, v223, v51
    v_cvt_pk_bf16_f32 v214, v220, v221
    v_cvt_pk_bf16_f32 v215, v222, v223
    v_mov_b32 v52, v204
    s_waitcnt lgkmcnt(4)
    v_mfma_f32_32x32x16_bf16 v[240:255], a[224:227], a[164:167], v[240:255]
    ds_read_b64_tr_b16 a[240:241], v17 offset:16384
    s_add_u32 s48, s48, 8192
    buffer_load_dwordx4 v[168:171], v40, s[28:31], s48 offen sc1
    v_mov_b32 v53, v204
    v_fmaak_f32 v44, v192, v42, 0xb5c1a2a0
    v_mfma_f32_32x32x16_bf16 v[224:239], a[224:227], a[160:163], v[224:239]
    ds_read_b64_tr_b16 a[242:243], v17 offset:16896
    v_fmaak_f32 v45, v193, v42, 0xb5c1a2a0
    v_fmaak_f32 v46, v194, v42, 0xb5c1a2a0
    v_fmaak_f32 v47, v195, v42, 0xb5c1a2a0
    v_permlane32_swap_b32 v52, v53
    v_mfma_f32_32x32x16_bf16 v[240:255], a[228:231], a[172:175], v[240:255]
    ds_read_b64_tr_b16 a[244:245], v17 offset:17408
    s_add_u32 s48, s48, 8192
    buffer_load_dwordx4 v[172:175], v40, s[28:31], s48 offen sc1
    v_exp_f32_e64 v44, v44 clamp
    v_mfma_f32_32x32x16_bf16 v[224:239], a[228:231], a[168:171], v[224:239]
    ds_read_b64_tr_b16 a[246:247], v17 offset:17920
    v_exp_f32_e64 v45, v45 clamp
    v_exp_f32_e64 v46, v46 clamp
    s_waitcnt lgkmcnt(4)
    v_mfma_f32_32x32x16_bf16 v[240:255], a[232:235], a[180:183], v[240:255]
    ds_read_b64_tr_b16 a[248:249], v17 offset:18432
    s_add_u32 s48, s48, 8192
    buffer_load_dwordx4 v[176:179], v40, s[28:31], s48 offen sc1
    v_exp_f32_e64 v47, v47 clamp
    v_mfma_f32_32x32x16_bf16 v[224:239], a[232:235], a[176:179], v[224:239]
    ds_read_b64_tr_b16 a[250:251], v17 offset:18944
    v_max_f32 v192, v43, v192
    v_max_f32 v193, v43, v193
    v_fmaak_f32 v52, v53, v42, 0xb5c1a2a0
    v_max_f32 v194, v43, v194
    v_max_f32 v195, v43, v195
    v_mfma_f32_32x32x16_bf16 v[240:255], a[236:239], a[188:191], v[240:255]
    ds_read_b64_tr_b16 a[252:253], v17 offset:19456
    s_add_u32 s48, s48, 8192
    buffer_load_dwordx4 v[180:183], v40, s[28:31], s48 offen sc1
    v_exp_f32_e64 v52, -v52
    v_mfma_f32_32x32x16_bf16 v[224:239], a[236:239], a[184:187], v[224:239]
    ds_read_b64_tr_b16 a[254:255], v17 offset:19968
    v_add_f32 v192, v192, v44
    v_add_f32 v193, v193, v45
    v_add_f32 v194, v194, v46
    v_add_f32 v195, v195, v47
    s_waitcnt lgkmcnt(4)
    v_mfma_f32_32x32x16_bf16 v[240:255], a[240:243], a[196:199], v[240:255]
    s_add_u32 s48, s48, 8192
    buffer_load_dwordx4 v[184:187], v40, s[28:31], s48 offen sc1
    v_add_f32 v52, 1.0, v52
    v_cvt_pk_bf16_f32 v192, v192, v193
    v_cvt_pk_bf16_f32 v193, v194, v195
    v_mfma_f32_32x32x16_bf16 v[224:239], a[240:243], a[192:195], v[224:239]
    v_rcp_f32 v53, v52
    v_fmaak_f32 v44, v196, v42, 0xb5c1a2a0
    v_fmaak_f32 v45, v197, v42, 0xb5c1a2a0
    v_fmaak_f32 v46, v198, v42, 0xb5c1a2a0
    v_fmaak_f32 v47, v199, v42, 0xb5c1a2a0
    v_mfma_f32_32x32x16_bf16 v[240:255], a[244:247], a[204:207], v[240:255]
    s_add_u32 s48, s48, 8192
    buffer_load_dwordx4 v[188:191], v40, s[28:31], s48 offen sc1
    v_sub_f32 v52, 1.0, v53
L_pad_att_2:
    s_cbranch_execz L_att_main
    v_exp_f32_e64 v44, v44 clamp
    v_mfma_f32_32x32x16_bf16 v[224:239], a[244:247], a[200:203], v[224:239]
    v_exp_f32_e64 v45, v45 clamp
    v_exp_f32_e64 v46, v46 clamp
    s_waitcnt lgkmcnt(0)
    v_mfma_f32_32x32x16_bf16 v[240:255], a[248:251], a[212:215], v[240:255]
    v_exp_f32_e64 v47, v47 clamp
    v_max_f32 v196, v43, v196
    v_max_f32 v197, v43, v197
    v_max_f32 v198, v43, v198
    v_max_f32 v199, v43, v199
    v_mfma_f32_32x32x16_bf16 v[224:239], a[248:251], a[208:211], v[224:239]
    v_add_f32 v196, v196, v44
    v_add_f32 v197, v197, v45
    v_add_f32 v198, v198, v46
    v_add_f32 v199, v199, v47
    v_cvt_pk_bf16_f32 v194, v196, v197
    v_cvt_pk_bf16_f32 v195, v198, v199
    v_mfma_f32_32x32x16_bf16 v[240:255], a[252:255], a[220:223], v[240:255]
    v_fmaak_f32 v44, v200, v42, 0xb5c1a2a0
    v_fmaak_f32 v45, v201, v42, 0xb5c1a2a0
    v_fmaak_f32 v46, v202, v42, 0xb5c1a2a0
    v_fmaak_f32 v47, v203, v42, 0xb5c1a2a0
    v_exp_f32_e64 v44, v44 clamp
    v_mfma_f32_32x32x16_bf16 v[224:239], a[252:255], a[216:219], v[224:239]
    v_exp_f32_e64 v45, v45 clamp
    v_exp_f32_e64 v46, v46 clamp
    v_exp_f32_e64 v47, v47 clamp
    v_max_f32 v200, v43, v200
    v_max_f32 v201, v43, v201
    v_max_f32 v202, v43, v202
    v_max_f32 v203, v43, v203
    v_add_f32 v200, v200, v44
    v_add_f32 v201, v201, v45
    v_add_f32 v202, v202, v46
    v_add_f32 v203, v203, v47
    v_cvt_pk_bf16_f32 v196, v200, v201
    v_cvt_pk_bf16_f32 v197, v202, v203
    v_fmaak_f32 v44, v204, v42, 0xb5c1a2a0
    v_fmaak_f32 v45, v205, v42, 0xb5c1a2a0
    v_fmaak_f32 v46, v206, v42, 0xb5c1a2a0
    v_fmaak_f32 v47, v207, v42, 0xb5c1a2a0
    v_exp_f32_e64 v44, v44 clamp
    v_exp_f32_e64 v45, v45 clamp
    v_exp_f32_e64 v46, v46 clamp
    v_exp_f32_e64 v47, v47 clamp
    v_max_f32 v204, v43, v204
    v_max_f32 v205, v43, v205
    v_max_f32 v206, v43, v206
    v_max_f32 v207, v43, v207
    v_add_f32 v204, v204, v44
    v_add_f32 v205, v205, v45
    v_add_f32 v206, v206, v46
    v_add_f32 v207, v207, v47
    v_cvt_pk_bf16_f32 v198, v204, v205
    v_cvt_pk_bf16_f32 v199, v206, v207
    s_mov_b32 exec_lo, 0
    v_mov_b32 v52, v54
    s_mov_b32 exec_lo, -1
    buffer_store_dword v52, v29, s[28:31], s73 offen sc1
    v_pk_fma_f32 v[48:49], v[240:241], v[36:37], v[36:37] op_sel:[0,0,1] op_sel_hi:[1,0,1]
    v_pk_fma_f32 v[50:51], v[242:243], v[36:37], v[36:37] op_sel:[0,0,1] op_sel_hi:[1,0,1]
    v_exp_f32_e64 v48, v48 clamp
    v_exp_f32_e64 v49, v49 clamp
    v_exp_f32_e64 v50, v50 clamp
    v_exp_f32_e64 v51, v51 clamp
    v_max_f32 v240, v43, v240
    v_max_f32 v241, v43, v241
    v_max_f32 v242, v43, v242
    v_max_f32 v243, v43, v243
    v_pk_add_f32 v[240:241], v[240:241], v[48:49]
    v_pk_add_f32 v[242:243], v[242:243], v[50:51]
    v_cvt_pk_bf16_f32 v240, v240, v241
    v_cvt_pk_bf16_f32 v241, v242, v243
    v_pk_fma_f32 v[48:49], v[244:245], v[36:37], v[36:37] op_sel:[0,0,1] op_sel_hi:[1,0,1]
    v_pk_fma_f32 v[50:51], v[246:247], v[36:37], v[36:37] op_sel:[0,0,1] op_sel_hi:[1,0,1]
    v_exp_f32_e64 v48, v48 clamp
    v_exp_f32_e64 v49, v49 clamp
    v_exp_f32_e64 v50, v50 clamp
    v_exp_f32_e64 v51, v51 clamp
    v_max_f32 v244, v43, v244
    v_max_f32 v245, v43, v245
    v_max_f32 v246, v43, v246
    v_max_f32 v247, v43, v247
    v_pk_add_f32 v[244:245], v[244:245], v[48:49]
    v_pk_add_f32 v[246:247], v[246:247], v[50:51]
    v_cvt_pk_bf16_f32 v242, v244, v245
    v_cvt_pk_bf16_f32 v243, v246, v247
    v_pk_fma_f32 v[48:49], v[248:249], v[36:37], v[36:37] op_sel:[0,0,1] op_sel_hi:[1,0,1]
    v_pk_fma_f32 v[50:51], v[250:251], v[36:37], v[36:37] op_sel:[0,0,1] op_sel_hi:[1,0,1]
    v_exp_f32_e64 v48, v48 clamp
    v_exp_f32_e64 v49, v49 clamp
    v_exp_f32_e64 v50, v50 clamp
    v_exp_f32_e64 v51, v51 clamp
    v_max_f32 v248, v43, v248
    v_max_f32 v249, v43, v249
    v_max_f32 v250, v43, v250
    v_max_f32 v251, v43, v251
    v_pk_add_f32 v[248:249], v[248:249], v[48:49]
    v_pk_add_f32 v[250:251], v[250:251], v[50:51]
    v_cvt_pk_bf16_f32 v244, v248, v249
    v_cvt_pk_bf16_f32 v245, v250, v251
    s_waitcnt vmcnt(7)
    v_mfma_f32_32x32x16_bf16 v[128:143], v[32:35], v[160:163], 0
    v_fmaak_f32 v48, v252, v42, 0xb5c1a2a0
    v_fmaak_f32 v49, v253, v42, 0xb5c1a2a0
    v_fmaak_f32 v50, v254, v42, 0xb5c1a2a0
    v_fmaak_f32 v51, v255, v42, 0xb5c1a2a0
    v_mfma_f32_32x32x16_bf16 v[128:143], v[32:35], v[164:167], v[128:143]
    v_exp_f32_e64 v48, v48 clamp
    v_exp_f32_e64 v49, v49 clamp
    s_waitcnt vmcnt(5)
    v_mfma_f32_32x32x16_bf16 v[128:143], v[32:35], v[168:171], v[128:143]
    v_exp_f32_e64 v50, v50 clamp
    v_exp_f32_e64 v51, v51 clamp
    v_max_f32 v252, v43, v252
    v_mfma_f32_32x32x16_bf16 v[128:143], v[32:35], v[172:175], v[128:143]
    v_max_f32 v253, v43, v253
    v_max_f32 v254, v43, v254
    v_max_f32 v255, v43, v255
    v_add_f32 v252, v252, v48
    v_add_f32 v253, v253, v49
    s_waitcnt vmcnt(3)
    v_mfma_f32_32x32x16_bf16 v[128:143], v[32:35], v[176:179], v[128:143]
    v_add_f32 v254, v254, v50
    v_add_f32 v255, v255, v51
    v_cvt_pk_bf16_f32 v246, v252, v253
    v_cvt_pk_bf16_f32 v247, v254, v255
    v_fmaak_f32 v44, v224, v42, 0xb5c1a2a0
    v_mfma_f32_32x32x16_bf16 v[128:143], v[32:35], v[180:183], v[128:143]
    v_fmaak_f32 v45, v225, v42, 0xb5c1a2a0
    v_fmaak_f32 v46, v226, v42, 0xb5c1a2a0
    v_fmaak_f32 v47, v227, v42, 0xb5c1a2a0
    v_exp_f32_e64 v44, v44 clamp
    s_waitcnt vmcnt(1)
    v_mfma_f32_32x32x16_bf16 v[128:143], v[32:35], v[184:187], v[128:143]
    v_exp_f32_e64 v45, v45 clamp
    v_exp_f32_e64 v46, v46 clamp
    v_mfma_f32_32x32x16_bf16 v[128:143], v[32:35], v[188:191], v[128:143]
    v_exp_f32_e64 v47, v47 clamp
    v_max_f32 v224, v43, v224
    v_max_f32 v225, v43, v225
    v_max_f32 v226, v43, v226
    v_max_f32 v227, v43, v227
    v_add_f32 v224, v224, v44
    v_add_f32 v225, v225, v45
    v_add_f32 v226, v226, v46
    v_add_f32 v227, v227, v47
    v_cvt_pk_bf16_f32 v224, v224, v225
    v_cvt_pk_bf16_f32 v225, v226, v227
    v_fmaak_f32 v44, v228, v42, 0xb5c1a2a0
    v_fmaak_f32 v45, v229, v42, 0xb5c1a2a0
    v_fmaak_f32 v46, v230, v42, 0xb5c1a2a0
    v_fmaak_f32 v47, v231, v42, 0xb5c1a2a0
    v_exp_f32_e64 v44, v44 clamp
    v_cmp_u_f32 vcc, v128, v128
    s_cbranch_vccnz L_slow_35
L_ok_34:
    v_cvt_pk_bf16_f32 v128, v128, v129
    v_cvt_pk_bf16_f32 v129, v130, v131
    v_cvt_pk_bf16_f32 v130, v132, v133
    v_cvt_pk_bf16_f32 v131, v134, v135
    v_cndmask_b32 v130, 0, v130, s[58:59]
    v_cndmask_b32 v131, 0, v131, s[58:59]
    ds_write_b128 v62, v[128:131]
    v_cmp_le_u32 vcc, 32, v0
    v_exp_f32_e64 v45, v45 clamp
    v_exp_f32_e64 v46, v46 clamp
    v_exp_f32_e64 v47, v47 clamp
    v_max_f32 v228, v43, v228
    v_max_f32 v229, v43, v229
    v_max_f32 v230, v43, v230
    v_max_f32 v231, v43, v231
    v_add_f32 v228, v228, v44
    v_add_f32 v229, v229, v45
    v_add_f32 v230, v230, v46
    s_waitcnt lgkmcnt(0)
    s_barrier
    ds_read_b128 v[72:75], v63 offset:2048
    ds_read_b128 v[76:79], v63 offset:3072
    ds_read_b128 v[64:67], v63 offset:0
    ds_read_b128 v[68:71], v63 offset:1024
    v_add_f32 v231, v231, v47
    v_cvt_pk_bf16_f32 v226, v228, v229
    v_cvt_pk_bf16_f32 v227, v230, v231
    v_fmaak_f32 v44, v232, v42, 0xb5c1a2a0
    v_fmaak_f32 v45, v233, v42, 0xb5c1a2a0
    v_fmaak_f32 v46, v234, v42, 0xb5c1a2a0
    v_fmaak_f32 v47, v235, v42, 0xb5c1a2a0
    v_exp_f32_e64 v44, v44 clamp
    v_exp_f32_e64 v45, v45 clamp
    v_exp_f32_e64 v46, v46 clamp
    v_exp_f32_e64 v47, v47 clamp
    v_max_f32 v232, v43, v232
    v_max_f32 v233, v43, v233
    v_max_f32 v234, v43, v234
    s_waitcnt lgkmcnt(2)
    v_mfma_f32_32x32x16_bf16 v[80:95], v[72:75], v[192:195], 0
    v_max_f32 v235, v43, v235
    v_add_f32 v232, v232, v44
    v_add_f32 v233, v233, v45
    v_add_f32 v234, v234, v46
    v_add_f32 v235, v235, v47
    v_cvt_pk_bf16_f32 v228, v232, v233
    v_mfma_f32_32x32x16_bf16 v[80:95], v[76:79], v[196:199], v[80:95]
    v_cvt_pk_bf16_f32 v229, v234, v235
    v_fmaak_f32 v44, v236, v42, 0xb5c1a2a0
    v_fmaak_f32 v45, v237, v42, 0xb5c1a2a0
    v_fmaak_f32 v46, v238, v42, 0xb5c1a2a0
    v_fmaak_f32 v47, v239, v42, 0xb5c1a2a0
    v_mfma_f32_32x32x16_bf16 v[96:111], v[72:75], v[208:211], 0
    v_exp_f32_e64 v44, v44 clamp
    v_exp_f32_e64 v45, v45 clamp
    v_exp_f32_e64 v46, v46 clamp
    v_mfma_f32_32x32x16_bf16 v[96:111], v[76:79], v[212:215], v[96:111]
    v_exp_f32_e64 v47, v47 clamp
    v_max_f32 v236, v43, v236
    v_max_f32 v237, v43, v237
    v_max_f32 v238, v43, v238
    v_max_f32 v239, v43, v239
    s_waitcnt lgkmcnt(0)
    v_mfma_f32_32x32x16_bf16 v[112:127], v[64:67], v[240:243], 0
    v_add_f32 v236, v236, v44
    v_add_f32 v237, v237, v45
    v_add_f32 v238, v238, v46
    v_add_f32 v239, v239, v47
    v_cvt_pk_bf16_f32 v230, v236, v237
    v_cvt_pk_bf16_f32 v231, v238, v239
    v_mfma_f32_32x32x16_bf16 v[112:127], v[68:71], v[244:247], v[112:127]
    s_nop 1
    v_mfma_f32_32x32x16_bf16 v[144:159], v[64:67], v[224:227], 0
    v_cndmask_b32 v25, 0, v92, vcc
    v_cndmask_b32 v27, 0, v108, vcc
    s_nop 1
    v_permlane32_swap_b32 v92, v25
    v_permlane32_swap_b32 v108, v27
    v_mfma_f32_32x32x16_bf16 v[144:159], v[68:71], v[228:231], v[144:159]
    v_add_f32 v25, v43, v25
    v_add_f32 v27, v43, v27
    v_rcp_f32 v25, v25
    v_rcp_f32 v27, v27
    s_nop 0
    v_mul_f32 v24, v25, v53
    v_mul_f32 v26, v27, v55
    s_mov_b64 exec, 0xffff
    buffer_store_dword v21, v23, s[28:31], s72 offen sc1
    s_mov_b64 exec, -1
    v_pk_mul_f32 v[80:81], v[24:25], v[80:81] op_sel_hi:[0,1]
    v_pk_mul_f32 v[82:83], v[24:25], v[82:83] op_sel_hi:[0,1]
    v_pk_mul_f32 v[84:85], v[24:25], v[84:85] op_sel_hi:[0,1]
    v_pk_mul_f32 v[86:87], v[24:25], v[86:87] op_sel_hi:[0,1]
    v_cvt_pk_bf16_f32 v80, v80, v81
    v_cvt_pk_bf16_f32 v81, v82, v83
    v_cvt_pk_bf16_f32 v82, v84, v85
    v_cvt_pk_bf16_f32 v83, v86, v87
    buffer_store_dwordx4 v[80:83], v41, s[28:31], s70 offen offset:1024 sc1
    v_pk_mul_f32 v[88:89], v[24:25], v[88:89] op_sel_hi:[0,1]
    v_pk_mul_f32 v[90:91], v[24:25], v[90:91] op_sel_hi:[0,1]
    v_pk_mul_f32 v[92:93], v[24:25], v[92:93] op_sel_hi:[0,1]
    v_pk_mul_f32 v[94:95], v[24:25], v[94:95] op_sel_hi:[0,1]
    v_cvt_pk_bf16_f32 v88, v88, v89
    v_cvt_pk_bf16_f32 v89, v90, v91
    v_cvt_pk_bf16_f32 v90, v92, v93
    v_cvt_pk_bf16_f32 v91, v94, v95
    buffer_store_dwordx4 v[88:91], v41, s[28:31], s70 offen offset:1536 sc1
    v_cndmask_b32 v29, 0, v124, vcc
    v_cndmask_b32 v31, 0, v156, vcc
    s_nop 1
    v_permlane32_swap_b32 v124, v29
    v_permlane32_swap_b32 v156, v31
    v_add_f32 v29, v43, v29
    v_add_f32 v31, v43, v31
    v_rcp_f32 v29, v29
    v_rcp_f32 v31, v31
    s_nop 0
    v_mul_f32 v28, v29, v55
    v_mul_f32 v30, v31, v53
    v_pk_mul_f32 v[96:97], v[26:27], v[96:97] op_sel_hi:[0,1]
    v_pk_mul_f32 v[98:99], v[26:27], v[98:99] op_sel_hi:[0,1]
    v_pk_mul_f32 v[100:101], v[26:27], v[100:101] op_sel_hi:[0,1]
    v_pk_mul_f32 v[102:103], v[26:27], v[102:103] op_sel_hi:[0,1]
    v_cvt_pk_bf16_f32 v96, v96, v97
    v_cvt_pk_bf16_f32 v97, v98, v99
    v_cvt_pk_bf16_f32 v98, v100, v101
    v_cvt_pk_bf16_f32 v99, v102, v103
    buffer_store_dwordx4 v[96:99], v41, s[28:31], s71 offen offset:1024 sc1
    v_pk_mul_f32 v[104:105], v[26:27], v[104:105] op_sel_hi:[0,1]
    v_pk_mul_f32 v[106:107], v[26:27], v[106:107] op_sel_hi:[0,1]
    v_pk_mul_f32 v[108:109], v[26:27], v[108:109] op_sel_hi:[0,1]
    v_pk_mul_f32 v[110:111], v[26:27], v[110:111] op_sel_hi:[0,1]
    v_cvt_pk_bf16_f32 v104, v104, v105
    v_cvt_pk_bf16_f32 v105, v106, v107
    v_cvt_pk_bf16_f32 v106, v108, v109
    v_cvt_pk_bf16_f32 v107, v110, v111
    buffer_store_dwordx4 v[104:107], v41, s[28:31], s71 offen offset:1536 sc1
    v_pk_mul_f32 v[112:113], v[28:29], v[112:113] op_sel_hi:[0,1]
    v_pk_mul_f32 v[114:115], v[28:29], v[114:115] op_sel_hi:[0,1]
    v_pk_mul_f32 v[116:117], v[28:29], v[116:117] op_sel_hi:[0,1]
    v_pk_mul_f32 v[118:119], v[28:29], v[118:119] op_sel_hi:[0,1]
    v_cvt_pk_bf16_f32 v112, v112, v113
    v_cvt_pk_bf16_f32 v113, v114, v115
    v_cvt_pk_bf16_f32 v114, v116, v117
    v_cvt_pk_bf16_f32 v115, v118, v119
    buffer_store_dwordx4 v[112:115], v41, s[28:31], s71 offen offset:0 sc1
    v_pk_mul_f32 v[120:121], v[28:29], v[120:121] op_sel_hi:[0,1]
    v_pk_mul_f32 v[122:123], v[28:29], v[122:123] op_sel_hi:[0,1]
    v_pk_mul_f32 v[124:125], v[28:29], v[124:125] op_sel_hi:[0,1]
    v_pk_mul_f32 v[126:127], v[28:29], v[126:127] op_sel_hi:[0,1]
    v_cvt_pk_bf16_f32 v120, v120, v121
    v_cvt_pk_bf16_f32 v121, v122, v123
    v_cvt_pk_bf16_f32 v122, v124, v125
    v_cvt_pk_bf16_f32 v123, v126, v127
    buffer_store_dwordx4 v[120:123], v41, s[28:31], s71 offen offset:512 sc1
    v_pk_mul_f32 v[144:145], v[30:31], v[144:145] op_sel_hi:[0,1]
    v_pk_mul_f32 v[146:147], v[30:31], v[146:147] op_sel_hi:[0,1]
    v_pk_mul_f32 v[148:149], v[30:31], v[148:149] op_sel_hi:[0,1]
    v_pk_mul_f32 v[150:151], v[30:31], v[150:151] op_sel_hi:[0,1]
    v_cvt_pk_bf16_f32 v144, v144, v145
    v_cvt_pk_bf16_f32 v145, v146, v147
    v_cvt_pk_bf16_f32 v146, v148, v149
    v_cvt_pk_bf16_f32 v147, v150, v151
    buffer_store_dwordx4 v[144:147], v41, s[28:31], s70 offen offset:0 sc1
    v_pk_mul_f32 v[152:153], v[30:31], v[152:153] op_sel_hi:[0,1]
    v_pk_mul_f32 v[154:155], v[30:31], v[154:155] op_sel_hi:[0,1]
    v_pk_mul_f32 v[156:157], v[30:31], v[156:157] op_sel_hi:[0,1]
    v_pk_mul_f32 v[158:159], v[30:31], v[158:159] op_sel_hi:[0,1]
    v_cvt_pk_bf16_f32 v152, v152, v153
    v_cvt_pk_bf16_f32 v153, v154, v155
    v_cvt_pk_bf16_f32 v154, v156, v157
    v_cvt_pk_bf16_f32 v155, v158, v159
    buffer_store_dwordx4 v[152:155], v41, s[28:31], s70 offen offset:512 sc1
    s_endpgm
L_slow_27:
    s_mov_b32 s55, 0
    global_load_dword v22, v20, s[36:37] sc1
L_chk_28:
    s_waitcnt vmcnt(0)
    v_cmp_ne_u32 vcc, 1, v22
    s_cbranch_vccz L_ok_29
    global_load_dword v22, v20, s[36:37] sc1
    s_add_u32 s55, s55, 1
    s_cmp_lt_u32 s55, 400000
    s_cbranch_scc1 L_chk_28
    s_branch L_ok_29
L_slow_30:
    s_mov_b32 s55, 0
    buffer_load_dword v39, v38, s[28:31], 0 offen sc1
    s_sleep 3
    buffer_load_dword v30, v38, s[28:31], 0 offen sc1
    s_sleep 3
    buffer_load_dword v31, v38, s[28:31], 0 offen sc1
L_chk_31:
    s_waitcnt vmcnt(2)
    v_cmp_ne_u32 vcc, 1, v39
    s_cbranch_vccz L_ok_32
    buffer_load_dword v39, v38, s[28:31], 0 offen sc1
    s_waitcnt vmcnt(2)
    v_cmp_ne_u32 vcc, 1, v30
    s_cbranch_vccz L_ok_32
    buffer_load_dword v30, v38, s[28:31], 0 offen sc1
    s_waitcnt vmcnt(2)
    v_cmp_ne_u32 vcc, 1, v31
    s_cbranch_vccz L_ok_32
    buffer_load_dword v31, v38, s[28:31], 0 offen sc1
    s_add_u32 s55, s55, 1
    s_cmp_lt_u32 s55, 400000
    s_cbranch_scc1 L_chk_31
    s_branch L_ok_32
L_slow_35:
    s_mov_b32 s55, 0
L_kvr_33:
    s_mov_b32 s48, s69
    buffer_load_dwordx4 v[160:163], v40, s[28:31], s48 offen sc1
    s_add_u32 s48, s48, 8192
    buffer_load_dwordx4 v[164:167], v40, s[28:31], s48 offen sc1
    s_add_u32 s48, s48, 8192
    buffer_load_dwordx4 v[168:171], v40, s[28:31], s48 offen sc1
    s_add_u32 s48, s48, 8192
    buffer_load_dwordx4 v[172:175], v40, s[28:31], s48 offen sc1
    s_add_u32 s48, s48, 8192
    buffer_load_dwordx4 v[176:179], v40, s[28:31], s48 offen sc1
    s_add_u32 s48, s48, 8192
    buffer_load_dwordx4 v[180:183], v40, s[28:31], s48 offen sc1
    s_add_u32 s48, s48, 8192
    buffer_load_dwordx4 v[184:187], v40, s[28:31], s48 offen sc1
    s_add_u32 s48, s48, 8192
    buffer_load_dwordx4 v[188:191], v40, s[28:31], s48 offen sc1
    s_add_u32 s55, s55, 1
    s_waitcnt vmcnt(0)
    v_max_u32 v128, v160, v161
    v_max3_u32 v128, v128, v162, v163
    v_max3_u32 v128, v128, v164, v165
    v_max3_u32 v128, v128, v166, v167
    v_max3_u32 v128, v128, v168, v169
    v_max3_u32 v128, v128, v170, v171
    v_max3_u32 v128, v128, v172, v173
    v_max3_u32 v128, v128, v174, v175
    v_max3_u32 v128, v128, v176, v177
    v_max3_u32 v128, v128, v178, v179
    v_max3_u32 v128, v128, v180, v181
    v_max3_u32 v128, v128, v182, v183
    v_max3_u32 v128, v128, v184, v185
    v_max3_u32 v128, v128, v186, v187
    v_max3_u32 v128, v128, v188, v189
    v_max3_u32 v128, v128, v190, v191
    v_cmp_eq_u32 vcc, -1, v128
    s_cmp_lt_u32 s55, 400000
    s_cselect_b64 s[0:1], -1, 0
    s_and_b64 vcc, vcc, s[0:1]
    s_cbranch_vccnz L_kvr_33
    v_mfma_f32_32x32x16_bf16 v[128:143], v[32:35], v[160:163], 0
    v_mfma_f32_32x32x16_bf16 v[128:143], v[32:35], v[164:167], v[128:143]
    v_mfma_f32_32x32x16_bf16 v[128:143], v[32:35], v[168:171], v[128:143]
    v_mfma_f32_32x32x16_bf16 v[128:143], v[32:35], v[172:175], v[128:143]
    v_mfma_f32_32x32x16_bf16 v[128:143], v[32:35], v[176:179], v[128:143]
    v_mfma_f32_32x32x16_bf16 v[128:143], v[32:35], v[180:183], v[128:143]
    v_mfma_f32_32x32x16_bf16 v[128:143], v[32:35], v[184:187], v[128:143]
    v_mfma_f32_32x32x16_bf16 v[128:143], v[32:35], v[188:191], v[128:143]
    s_nop 11
    s_branch L_ok_34
L_help:
    s_load_dwordx2 s[20:21], s[0:1], 48
    s_load_dwordx2 s[24:25], s[0:1], 16
    s_load_dwordx2 s[28:29], s[0:1], 80
    s_load_dwordx2 s[36:37], s[0:1], 72
    s_lshl_b32 s48, s40, 6
    v_add_u32 v1, s48, v0
    v_lshlrev_b32 v4, 7, v1
    v_mov_b32 v2, 0
    v_mov_b32 v3, 1
    s_waitcnt lgkmcnt(0)
    s_mov_b32 s30, 20971520
    s_mov_b32 s31, 0x20000
    s_mov_b32 s22, 1605632
    s_mov_b32 s23, 0x20000
    s_mov_b32 s26, 401408
    s_mov_b32 s27, 0x20000
    v_mov_b32 v12, 0
    v_mov_b32 v20, -1
    v_mov_b32 v13, 0
    v_mov_b32 v21, -1
    v_mov_b32 v14, 0
    v_mov_b32 v22, -1
    v_mov_b32 v15, 0
    v_mov_b32 v23, -1
    v_lshlrev_b32 v11, 4, v1
    s_lshl_b32 s48, s2, 15
    s_add_u32 s48, s48, 11599872
    buffer_store_dwordx4 v[12:15], v11, s[28:31], s48 offen sc1
    s_add_u32 s48, s48, 4096
    buffer_store_dwordx4 v[12:15], v11, s[28:31], s48 offen sc1
    s_add_u32 s48, s48, 4096
    buffer_store_dwordx4 v[12:15], v11, s[28:31], s48 offen sc1
    s_add_u32 s48, s48, 4096
    buffer_store_dwordx4 v[12:15], v11, s[28:31], s48 offen sc1
    s_add_u32 s48, s48, 4096
    buffer_store_dwordx4 v[12:15], v11, s[28:31], s48 offen sc1
    s_add_u32 s48, s48, 4096
    buffer_store_dwordx4 v[12:15], v11, s[28:31], s48 offen sc1
    s_add_u32 s48, s48, 4096
    buffer_store_dwordx4 v[12:15], v11, s[28:31], s48 offen sc1
    s_add_u32 s48, s48, 4096
    buffer_store_dwordx4 v[12:15], v11, s[28:31], s48 offen sc1
    s_add_u32 s48, s48, 4096
    s_lshl_b32 s48, s2, 11
    s_add_u32 s48, s48, 11534336
    v_lshlrev_b32 v17, 3, v1
    buffer_store_dwordx2 v[20:21], v17, s[28:31], s48 offen sc1
    s_mov_b32 s18, 1204224
    s_mov_b32 s19, 0x20000
    v_lshrrev_b32 v8, 1, v1
    v_mul_u32_u24 v8, 2688, v8
    v_and_b32 v9, 1, v1
    v_mul_u32_u24 v9, 896, v9
    v_add_u32 v8, v8, v9
    v_mul_u32_u24 v9, 2688, v1
    s_add_u32 s50, s3, 1
    s_cmp_ge_u32 s50, 7
    s_cselect_b32 s51, 7, 0
    s_sub_u32 s50, s50, s51
    s_mul_i32 s49, s50, 172032
    buffer_load_dword v40, v8, s[16:19], s49 offen offset:1280
    s_cmp_eq_u32 s50, 6
    s_cselect_b32 s51, 1, 2
    s_add_u32 s50, s50, s51
    s_cmp_ge_u32 s50, 7
    s_cselect_b32 s51, 7, 0
    s_sub_u32 s50, s50, s51
    s_mul_i32 s49, s50, 172032
    buffer_load_dword v41, v8, s[16:19], s49 offen offset:1280
    s_cmp_eq_u32 s50, 6
    s_cselect_b32 s51, 1, 2
    s_add_u32 s50, s50, s51
    s_cmp_ge_u32 s50, 7
    s_cselect_b32 s51, 7, 0
    s_sub_u32 s50, s50, s51
    s_mul_i32 s49, s50, 172032
    buffer_load_dword v42, v8, s[16:19], s49 offen offset:1280
    s_cmp_eq_u32 s50, 6
    s_cselect_b32 s51, 1, 2
    s_add_u32 s50, s50, s51
    s_cmp_ge_u32 s50, 7
    s_cselect_b32 s51, 7, 0
    s_sub_u32 s50, s50, s51
    s_mul_i32 s49, s50, 172032
    buffer_load_dword v43, v8, s[16:19], s49 offen offset:1280
    s_cmp_eq_u32 s50, 6
    s_cselect_b32 s51, 1, 2
    s_add_u32 s50, s50, s51
    s_lshl_b32 s3, s2, 2
    v_mov_b32 v16, s3
    s_waitcnt vmcnt(4)
    s_barrier
    s_cmp_lg_u32 s40, 0
    s_cbranch_scc1 L_help0
    s_mov_b64 exec, 1
    global_store_dword v16, v3, s[36:37] sc1
    s_mov_b64 exec, -1
L_help0:
    s_mov_b32 s49, 384
    buffer_load_dword v44, v9, s[16:19], s49 offen
    s_mov_b32 s49, 688512
    buffer_load_dword v45, v9, s[16:19], s49 offen
    s_and_b32 s48, s2, 1
    s_lshl_b32 s48, s48, 9
    s_add_u32 s49, s48, 0
    buffer_load_dword v46, v9, s[16:19], s49 offen
    s_add_u32 s49, s48, 128
    buffer_load_dword v47, v9, s[16:19], s49 offen
    s_add_u32 s49, s48, 256
    buffer_load_dword v48, v9, s[16:19], s49 offen
    s_add_u32 s49, s48, 688128
    buffer_load_dword v49, v9, s[16:19], s49 offen
    s_add_u32 s49, s48, 688256
    buffer_load_dword v50, v9, s[16:19], s49 offen
    s_add_u32 s49, s48, 688384
    buffer_load_dword v51, v9, s[16:19], s49 offen
L_exit:
    s_endpgm
.section .rodata,"a"
.p2align 6
.amdhsa_kernel gated_mix__linear_attn_block__glu_gated_reglu__prompt_kernel
  .amdhsa_next_free_vgpr 512
  .amdhsa_next_free_sgpr 102
  .amdhsa_accum_offset 256
  .amdhsa_group_segment_fixed_size 0
  .amdhsa_kernarg_size 88
  .amdhsa_user_sgpr_count 2
  .amdhsa_user_sgpr_kernarg_segment_ptr 1
  .amdhsa_system_sgpr_workgroup_id_x 1
.end_amdhsa_kernel
```
